```python
import torch

def _softmax(x, axis=-1):
    return torch.softmax(x, dim=axis)

def _gelu(x):
    return torch.nn.functional.gelu(x, approximate='tanh')

def _silu(x):
    return torch.nn.functional.silu(x)

def _sigmoid(x):
    return torch.sigmoid(x)

def _layernorm(x, axis=-1, eps=1e-05):
    m = x.mean(dim=axis, keepdim=True)
    v = x.var(dim=axis, keepdim=True, unbiased=False)
    return (x - m) / torch.sqrt(v + eps)

def _scatter_add(tgt, idx, src, axis=0):
    return tgt.clone().index_add_(axis, idx, src)

def _segment_sum(src, seg, n):
    out = torch.zeros((n,) + src.shape[1:], dtype=src.dtype)
    return out.index_add_(0, seg, src)

def _pad(x, pw):
    flat = tuple((v for pair in reversed(pw) for v in pair))
    return torch.nn.functional.pad(x, flat)
kernel_name = 'adaLN_cond__gqa_block_cached__geglu_ffn__decode'

def setup_inputs():

    _w = lambda a: (lambda t: t.to(torch.bfloat16) if t.is_floating_point() else t)(torch.as_tensor(a))

    def _A_setup():
        B, Sq, D = (4, 1, 512)
        Hq, Hkv, Sk, Dh = (32, 8, 8192, 128)
        assert Hq % Hkv == 0, (Hq, Hkv)
        return {'x': _w((lambda *s: torch.randn(*s, dtype=torch.bfloat16) * 0.1)(B, Sq, D)), 'k_cache': _w((lambda *s: torch.randn(*s, dtype=torch.bfloat16) * 0.8)(B, Hkv, Sk, Dh)), 'v_cache': _w((lambda *s: torch.randn(*s, dtype=torch.bfloat16) * 1.6)(B, Hkv, Sk, Dh)), 'wq': _w((lambda *s: torch.randn(*s, dtype=torch.bfloat16) * 0.8)(D, Hq * Dh) * D ** (-0.5)), 'wo': _w((lambda *s: torch.randn(*s, dtype=torch.bfloat16) * 1.6)(Hq * Dh, D) * (Hq * Dh) ** (-0.5))}
    _A_in = _A_setup()

    def _B_setup():
        B, S, D, F = (4, 1, 512, 1792)
        return {'x': _w((lambda *s: torch.randn(*s, dtype=torch.bfloat16) * 0.1)(B, S, D)), 'w_gate': _w((lambda *s: torch.randn(*s, dtype=torch.bfloat16) * 0.1)(D, F)), 'w_up': _w((lambda *s: torch.randn(*s, dtype=torch.bfloat16) * 0.1)(D, F)), 'w_down': _w((lambda *s: torch.randn(*s, dtype=torch.bfloat16) * 0.1)(F, D))}
    _B_in = _B_setup()
    return {'A_x': _A_in['x'], 'A_k_cache': _A_in['k_cache'], 'A_v_cache': _A_in['v_cache'], 'A_wq': _A_in['wq'], 'A_wo': _A_in['wo'], 'B_x': _B_in['x'], 'B_w_gate': _B_in['w_gate'], 'B_w_up': _B_in['w_up'], 'B_w_down': _B_in['w_down'], 'c': _w((lambda *s: torch.randn(*s, dtype=torch.bfloat16) * 0.8)(4, 512) * 8.0), 'w_mod': _w((lambda *s: torch.randn(*s, dtype=torch.bfloat16) * 0.8)(512, 6 * 512) * 512 ** (-0.5) * 8.0)}

def reference(A_x, A_k_cache, A_v_cache, A_wq, A_wo, B_x, B_w_gate, B_w_up, B_w_down, c, w_mod):

    def _A_ref(x, k_cache, v_cache, wq, wo):
        B, Sq, D = x.shape
        Hq, Dh = (32, 128)
        Hkv = k_cache.shape[1]
        rep = Hq // Hkv
        q = (lambda x, *d: x.permute(*d))((x @ wq).reshape(B, Sq, Hq, Dh), 0, 2, 1, 3)
        k = (lambda x, n, axis: torch.repeat_interleave(x, n, dim=axis))(k_cache, rep, axis=1)
        v = (lambda x, n, axis: torch.repeat_interleave(x, n, dim=axis))(v_cache, rep, axis=1)
        scores = torch.einsum('bhqd,bhkd->bhqk', q, k) * Dh ** (-0.5)
        p = _softmax(scores, axis=-1)
        o = torch.einsum('bhqk,bhkd->bhqd', p, v)
        return (lambda x, *d: x.permute(*d))(o, 0, 2, 1, 3).reshape(B, Sq, Hq * Dh) @ wo

    def _B_ref(x, w_gate, w_up, w_down):
        return _gelu(x @ w_gate) * (x @ w_up) @ w_down
    x = A_x
    mod = (_silu(c) @ w_mod).reshape(c.shape[0], 6, 1, -1)
    sa, ca, ga, sb, cb, gb = (mod[:, 0].clone(), mod[:, 1].clone(), mod[:, 2].clone(), mod[:, 3].clone(), mod[:, 4].clone(), mod[:, 5].clone())
    h = _layernorm(x, axis=-1) * (1 + ca) + sa
    x = x + ga * _A_ref(h, A_k_cache, A_v_cache, A_wq, A_wo)
    h = _layernorm(x, axis=-1) * (1 + cb) + sb
    x = x + gb * _B_ref(h, B_w_gate, B_w_up, B_w_down)
    return x
```

```asm
; @launch grid=(256,1,1) block=(512,1,1) lds=163840
.amdgcn_target "amdgcn-amd-amdhsa--gfx950"
.text
.globl adaLN_cond__gqa_block_cached__geglu_ffn__decode_kernel
.p2align 8
.type adaLN_cond__gqa_block_cached__geglu_ffn__decode_kernel,@function
adaLN_cond__gqa_block_cached__geglu_ffn__decode_kernel:
  s_cmp_ge_u32 s2, 256
  s_cbranch_scc1 L_exit
  s_load_dwordx16 s[36:51], s[0:1], 0
  s_load_dwordx8 s[52:59], s[0:1], 64
  s_load_dwordx4 s[60:63], s[0:1], 96
  v_lshrrev_b32 v2, 6, v0
  v_and_b32 v1, 63, v0
  v_readfirstlane_b32 s3, v2
  s_lshr_b32 s20, s2, 3
  s_and_b32 s21, s2, 7
  s_mov_b32 s2, s20
  s_cmp_eq_u32 s21, 0
  s_cbranch_scc1 L_erole
  s_mul_i32 s22, s20, 37
  s_lshr_b32 s22, s22, 8
  s_mul_i32 s22, s22, 7
  s_sub_u32 s22, s20, s22
  s_sub_u32 s21, s21, 1
  s_add_u32 s2, s20, 32
  s_cmp_eq_u32 s21, s22
  s_cbranch_scc1 L_qrole
  s_cmp_gt_u32 s21, s22
  s_cselect_b32 s22, 1, 0
  s_sub_u32 s21, s21, s22
  s_mul_i32 s23, s3, 6
  s_add_u32 s23, s23, s21
  s_mul_i32 s23, s23, 1024
  s_lshr_b32 s25, s20, 3
  s_and_b32 s26, s20, 7
  s_lshl_b32 s24, s20, 21
  v_lshlrev_b32 v3, 4, v1
  v_and_b32 v2, 12, v1
  v_lshlrev_b32 v2, 6, v2
  v_and_b32 v4, 48, v1
  v_lshl_add_u32 v2, v4, 2, v2
  v_and_b32 v4, 3, v1
  v_lshl_add_u32 v2, v4, 4, v2
  s_waitcnt lgkmcnt(0)
  s_add_u32 s4, s38, s24
  s_addc_u32 s5, s39, 0
  s_mov_b32 s6, 0x200000
  s_mov_b32 s7, 0x20000
  s_add_u32 s8, s40, s24
  s_addc_u32 s9, s41, 0
  s_mov_b32 s10, 0x200000
  s_mov_b32 s11, 0x20000
  s_mov_b32 s22, s23
  s_mov_b32 s78, 49152
  buffer_load_dwordx4 v[200:203], v2, s[4:7], s22 offen nt
  s_add_u32 s22, s22, s78
  buffer_load_dwordx4 v[204:207], v2, s[4:7], s22 offen nt
  s_add_u32 s22, s22, s78
  buffer_load_dwordx4 v[208:211], v2, s[4:7], s22 offen nt
  s_add_u32 s22, s22, s78
  s_mov_b32 s12, s62
  s_mov_b32 s13, s63
  s_mov_b32 s14, 0x400000
  s_mov_b32 s15, 0x20000
  s_mov_b32 s16, s60
  s_mov_b32 s17, s61
  s_mov_b32 s18, 0x100
  s_mov_b32 s19, 0x20000
  s_mov_b32 s27, 0x05040100
  s_mov_b32 s28, 0x07060302
  s_mov_b32 s30, 0x3fb8aa3b
  s_mov_b32 s29, 0x3db504f3
  v_lshlrev_b32 v6, 8, v4
  v_lshrrev_b32 v7, 2, v1
  v_lshl_add_u32 v6, v7, 4, v6
  v_lshrrev_b32 v5, 5, v1
  v_mul_u32_u24 v5, 136, v5
  s_lshl_b32 s65, s25, 13
  s_lshl_b32 s66, s26, 10
  s_add_u32 s65, s65, s66
  s_add_u32 s65, s65, 65536
  s_mul_i32 s64, s20, 40960
  s_add_u32 s64, s64, 171520
  s_cmp_eq_u32 s21, 7
  s_cselect_b32 s91, 1769472, -1
  v_mov_b32 v240, 0xff800000
  v_mov_b32 v241, 0xff800000
  v_mov_b32 v242, 0xff800000
  v_mov_b32 v243, 0xff800000
  v_mov_b32 v252, 0
  ds_write_b32 v252, v252 offset:26616
  s_waitcnt lgkmcnt(0)
  s_waitcnt vmcnt(2)
  buffer_load_dwordx4 v[212:215], v2, s[4:7], s22 offen nt
  s_add_u32 s22, s22, s78
  s_waitcnt vmcnt(2)
  buffer_load_dwordx4 v[8:11], v2, s[4:7], s22 offen nt
  s_add_u32 s22, s22, s78
  s_waitcnt vmcnt(2)
  buffer_load_dwordx4 v[12:15], v2, s[4:7], s22 offen nt
  s_add_u32 s22, s22, s78
  s_waitcnt vmcnt(2)
  buffer_load_dwordx4 v[16:19], v2, s[4:7], s22 offen nt
  s_add_u32 s22, s22, s78
  s_waitcnt vmcnt(2)
  buffer_load_dwordx4 v[20:23], v2, s[4:7], s22 offen nt
  s_add_u32 s22, s22, s78
  s_waitcnt vmcnt(2)
  buffer_load_dwordx4 v[24:27], v2, s[4:7], s22 offen nt
  s_add_u32 s22, s22, s78
  s_waitcnt vmcnt(2)
  buffer_load_dwordx4 v[28:31], v2, s[4:7], s22 offen nt
  s_add_u32 s22, s22, s78
  s_waitcnt vmcnt(2)
  buffer_load_dwordx4 v[32:35], v2, s[4:7], s22 offen nt
  s_add_u32 s22, s22, s78
  s_waitcnt vmcnt(2)
  buffer_load_dwordx4 v[36:39], v2, s[4:7], s22 offen nt
  s_add_u32 s22, s22, s78
  s_waitcnt vmcnt(2)
  buffer_load_dwordx4 v[40:43], v2, s[4:7], s22 offen nt
  s_add_u32 s22, s22, s78
  s_waitcnt vmcnt(2)
  buffer_load_dwordx4 v[44:47], v2, s[4:7], s22 offen nt
  s_add_u32 s22, s22, s78
  s_waitcnt vmcnt(2)
  buffer_load_dwordx4 v[48:51], v2, s[4:7], s22 offen nt
  s_add_u32 s22, s22, s78
  s_waitcnt vmcnt(2)
  buffer_load_dwordx4 v[52:55], v2, s[4:7], s22 offen nt
  s_add_u32 s22, s22, s78
  s_waitcnt vmcnt(2)
  buffer_load_dwordx4 v[56:59], v2, s[4:7], s22 offen nt
  s_add_u32 s22, s22, s78
  s_waitcnt vmcnt(2)
  buffer_load_dwordx4 v[60:63], v2, s[4:7], s22 offen nt
  s_add_u32 s22, s22, s78
  s_waitcnt vmcnt(2)
  buffer_load_dwordx4 v[64:67], v2, s[4:7], s22 offen nt
  s_add_u32 s22, s22, s78
  s_waitcnt vmcnt(2)
  buffer_load_dwordx4 v[68:71], v2, s[4:7], s22 offen nt
  s_add_u32 s22, s22, s78
  s_waitcnt vmcnt(2)
  buffer_load_dwordx4 v[72:75], v2, s[4:7], s22 offen nt
  s_add_u32 s22, s22, s78
  s_waitcnt vmcnt(2)
  buffer_load_dwordx4 v[76:79], v2, s[4:7], s22 offen nt
  s_add_u32 s22, s22, s78
  s_waitcnt vmcnt(2)
  buffer_load_dwordx4 v[80:83], v2, s[4:7], s22 offen nt
  s_add_u32 s22, s22, s78
  s_waitcnt vmcnt(2)
  buffer_load_dwordx4 v[84:87], v2, s[4:7], s22 offen nt
  s_add_u32 s22, s22, s78
  buffer_load_dwordx4 v[88:91], v2, s[4:7], s22 offen nt
  s_add_u32 s22, s22, s78
  buffer_load_dwordx4 v[92:95], v2, s[4:7], s22 offen nt
  s_add_u32 s22, s22, s78
  s_waitcnt vmcnt(4)
  buffer_load_dwordx4 v[96:99], v2, s[4:7], s22 offen nt
  s_add_u32 s22, s22, s78
  s_waitcnt vmcnt(4)
  buffer_load_dwordx4 v[100:103], v2, s[4:7], s22 offen nt
  s_waitcnt vmcnt(4)
  buffer_load_dwordx4 v[216:219], v3, s[8:11], s23 offen nt
  s_add_u32 s23, s23, s78
  s_waitcnt vmcnt(4)
  buffer_load_dwordx4 v[220:223], v3, s[8:11], s23 offen nt
  s_add_u32 s23, s23, s78
  s_waitcnt vmcnt(4)
  buffer_load_dwordx4 v[224:227], v3, s[8:11], s23 offen nt
  s_add_u32 s23, s23, s78
  s_waitcnt vmcnt(4)
  buffer_load_dwordx4 v[228:231], v3, s[8:11], s23 offen nt
  s_add_u32 s23, s23, s78
  s_waitcnt vmcnt(4)
  buffer_load_dwordx4 v[104:107], v3, s[8:11], s23 offen nt
  s_add_u32 s23, s23, s78
  s_waitcnt vmcnt(4)
  buffer_load_dwordx4 v[108:111], v3, s[8:11], s23 offen nt
  s_add_u32 s23, s23, s78
  s_waitcnt vmcnt(4)
  buffer_load_dwordx4 v[112:115], v3, s[8:11], s23 offen nt
  s_add_u32 s23, s23, s78
  s_waitcnt vmcnt(4)
  buffer_load_dwordx4 v[116:119], v3, s[8:11], s23 offen nt
  s_add_u32 s23, s23, s78
  s_waitcnt vmcnt(4)
  buffer_load_dwordx4 v[120:123], v3, s[8:11], s23 offen nt
  s_add_u32 s23, s23, s78
  s_waitcnt vmcnt(4)
  buffer_load_dwordx4 v[124:127], v3, s[8:11], s23 offen nt
  s_add_u32 s23, s23, s78
  s_waitcnt vmcnt(4)
  buffer_load_dwordx4 v[128:131], v3, s[8:11], s23 offen nt
  s_add_u32 s23, s23, s78
  s_waitcnt vmcnt(4)
  buffer_load_dwordx4 v[132:135], v3, s[8:11], s23 offen nt
  s_add_u32 s23, s23, s78
  s_waitcnt vmcnt(4)
  buffer_load_dwordx4 v[136:139], v3, s[8:11], s23 offen nt
  s_add_u32 s23, s23, s78
  s_waitcnt vmcnt(4)
  buffer_load_dwordx4 v[140:143], v3, s[8:11], s23 offen nt
  s_add_u32 s23, s23, s78
  s_waitcnt vmcnt(4)
  buffer_load_dwordx4 v[144:147], v3, s[8:11], s23 offen nt
  s_add_u32 s23, s23, s78
  s_waitcnt vmcnt(4)
  buffer_load_dwordx4 v[148:151], v3, s[8:11], s23 offen nt
  s_add_u32 s23, s23, s78
  s_waitcnt vmcnt(4)
  buffer_load_dwordx4 v[152:155], v3, s[8:11], s23 offen nt
  s_add_u32 s23, s23, s78
  buffer_load_dword v252, v5, s[16:19], 0 offen sc1
  s_waitcnt vmcnt(4)
  buffer_load_dwordx4 v[156:159], v3, s[8:11], s23 offen nt
  s_add_u32 s23, s23, s78
  s_waitcnt vmcnt(4)
  buffer_load_dwordx4 v[160:163], v3, s[8:11], s23 offen nt
  s_add_u32 s23, s23, s78
  s_waitcnt vmcnt(4)
  buffer_load_dwordx4 v[164:167], v3, s[8:11], s23 offen nt
  s_add_u32 s23, s23, s78
  s_waitcnt vmcnt(4)
  buffer_load_dwordx4 v[168:171], v3, s[8:11], s23 offen nt
  s_add_u32 s23, s23, s78
  s_waitcnt vmcnt(4)
  buffer_load_dwordx4 v[172:175], v3, s[8:11], s23 offen nt
  s_add_u32 s23, s23, s78
  s_waitcnt vmcnt(4)
  buffer_load_dwordx4 v[176:179], v3, s[8:11], s23 offen nt
  s_add_u32 s23, s23, s78
  s_mov_b32 s31, 0
  s_branch L_pfc3
L_pf1:
  buffer_load_dword v252, v5, s[16:19], 0 offen sc1
  s_waitcnt vmcnt(0)
L_pfc3:
  v_cmp_gt_u32 vcc, 0x40000000, v252
  s_cbranch_vccz L_pfd2
  s_add_u32 s31, s31, 1
  s_cmp_ge_u32 s31, 131072
  s_cbranch_scc1 L_pfd2
  s_sleep 8
  s_branch L_pf1
L_pfd2:
  s_barrier
  buffer_load_dwordx4 v[232:235], v6, s[12:15], s65 offen sc1
  v_mov_b32 v253, 1
  s_mov_b64 exec, 1
  buffer_atomic_add v253, off, s[12:15], s64 sc0 sc1
  s_mov_b64 exec, -1
  s_waitcnt vmcnt(4)
  buffer_load_dwordx4 v[180:183], v3, s[8:11], s23 offen nt
  s_add_u32 s23, s23, s78
  s_waitcnt vmcnt(4)
  buffer_load_dwordx4 v[184:187], v3, s[8:11], s23 offen nt
  s_add_u32 s23, s23, s78
  s_waitcnt vmcnt(4)
  buffer_load_dwordx4 v[188:191], v3, s[8:11], s23 offen nt
  s_add_u32 s23, s23, s78
  s_waitcnt vmcnt(4)
  buffer_load_dwordx4 v[192:195], v3, s[8:11], s23 offen nt
  s_add_u32 s23, s23, s78
  s_waitcnt vmcnt(4)
  buffer_load_dwordx4 v[196:199], v3, s[8:11], s23 offen nt
  v_max3_u32 v252, v232, v233, v234
  v_max_u32 v252, v252, v235
  v_cmp_eq_u32 vcc, -1, v252
  s_cbranch_vccz L_qok4
  s_mov_b32 s31, 0
L_pd5:
  buffer_load_dwordx4 v[232:235], v6, s[12:15], s65 offen sc1
  s_waitcnt vmcnt(0)
  v_max3_u32 v252, v232, v233, v234
  v_max_u32 v252, v252, v235
  v_cmp_eq_u32 vcc, -1, v252
  s_cbranch_vccz L_pdd6
  s_add_u32 s31, s31, 1
  s_cmp_ge_u32 s31, 131072
  s_cbranch_scc1 L_pdd6
  s_sleep 4
  s_branch L_pd5
L_pdd6:
L_qok4:
  v_mfma_f32_16x16x32_bf16 v[200:203], v[200:203], v[232:235], 0
  v_mfma_f32_16x16x32_bf16 v[204:207], v[204:207], v[232:235], 0
  v_mfma_f32_16x16x32_bf16 v[208:211], v[208:211], v[232:235], 0
  v_mfma_f32_16x16x32_bf16 v[212:215], v[212:215], v[232:235], 0
  v_mfma_f32_16x16x32_bf16 v[8:11], v[8:11], v[232:235], 0
  v_mfma_f32_16x16x32_bf16 v[12:15], v[12:15], v[232:235], 0
  v_mfma_f32_16x16x32_bf16 v[16:19], v[16:19], v[232:235], 0
  s_nop 1
  v_add_f32_dpp v236, v200, v203 row_ror:12 row_mask:0xf bank_mask:0x8
  v_add_f32_dpp v237, v204, v207 row_ror:12 row_mask:0xf bank_mask:0x8
  v_add_f32_dpp v238, v208, v211 row_ror:12 row_mask:0xf bank_mask:0x8
  v_mfma_f32_16x16x32_bf16 v[20:23], v[20:23], v[232:235], 0
  v_add_f32_dpp v236, v201, v236 row_ror:8 row_mask:0xf bank_mask:0x8
  v_add_f32_dpp v237, v205, v237 row_ror:8 row_mask:0xf bank_mask:0x8
  v_add_f32_dpp v238, v209, v238 row_ror:8 row_mask:0xf bank_mask:0x8
  v_mfma_f32_16x16x32_bf16 v[24:27], v[24:27], v[232:235], 0
  v_add_f32_dpp v236, v202, v236 row_ror:4 row_mask:0xf bank_mask:0x8
  v_add_f32_dpp v237, v206, v237 row_ror:4 row_mask:0xf bank_mask:0x8
  v_add_f32_dpp v238, v210, v238 row_ror:4 row_mask:0xf bank_mask:0x8
  v_mfma_f32_16x16x32_bf16 v[28:31], v[28:31], v[232:235], 0
  v_add_f32_dpp v239, v212, v215 row_ror:12 row_mask:0xf bank_mask:0x8
  v_add_f32_dpp v236, v9, v8 row_ror:12 row_mask:0xf bank_mask:0x1
  v_add_f32_dpp v237, v13, v12 row_ror:12 row_mask:0xf bank_mask:0x1
  v_mfma_f32_16x16x32_bf16 v[32:35], v[32:35], v[232:235], 0
  v_add_f32_dpp v239, v213, v239 row_ror:8 row_mask:0xf bank_mask:0x8
  v_add_f32_dpp v236, v10, v236 row_ror:8 row_mask:0xf bank_mask:0x1
  v_add_f32_dpp v237, v14, v237 row_ror:8 row_mask:0xf bank_mask:0x1
  v_mfma_f32_16x16x32_bf16 v[36:39], v[36:39], v[232:235], 0
  v_add_f32_dpp v239, v214, v239 row_ror:4 row_mask:0xf bank_mask:0x8
  v_add_f32_dpp v236, v11, v236 row_ror:4 row_mask:0xf bank_mask:0x1
  v_add_f32_dpp v237, v15, v237 row_ror:4 row_mask:0xf bank_mask:0x1
  v_readfirstlane_b32 s22, v253
  s_nop 0
  s_add_u32 s22, s22, 9
  s_cmp_ge_u32 s22, 176
  s_cbranch_scc1 L_tn7
  s_mul_i32 s22, s22, 4096
  s_add_u32 s22, s22, 1376256
  buffer_load_dwordx4 v[200:203], v2, s[4:7], s22 offen offset:0 nt
  buffer_load_dwordx4 v[204:207], v2, s[4:7], s22 offen offset:1024 nt
  buffer_load_dwordx4 v[208:211], v2, s[4:7], s22 offen offset:2048 nt
  buffer_load_dwordx4 v[212:215], v2, s[4:7], s22 offen offset:3072 nt
  v_mov_b32 v253, 1
  s_mov_b64 exec, 1
  buffer_atomic_add v253, off, s[12:15], s64 sc0 sc1
  s_mov_b64 exec, -1
  s_mov_b32 s77, 1
  s_branch L_tj8
L_tn7:
  s_mov_b32 s77, 0
L_tj8:
  v_mfma_f32_16x16x32_bf16 v[40:43], v[40:43], v[232:235], 0
  v_add_f32_dpp v238, v17, v16 row_ror:12 row_mask:0xf bank_mask:0x1
  v_add_f32_dpp v239, v21, v20 row_ror:12 row_mask:0xf bank_mask:0x1
  v_add_f32_dpp v240, v25, v24 row_ror:12 row_mask:0xf bank_mask:0x1
  v_mfma_f32_16x16x32_bf16 v[44:47], v[44:47], v[232:235], 0
  v_add_f32_dpp v238, v18, v238 row_ror:8 row_mask:0xf bank_mask:0x1
  v_add_f32_dpp v239, v22, v239 row_ror:8 row_mask:0xf bank_mask:0x1
  v_add_f32_dpp v240, v26, v240 row_ror:8 row_mask:0xf bank_mask:0x1
  v_mfma_f32_16x16x32_bf16 v[48:51], v[48:51], v[232:235], 0
  v_add_f32_dpp v238, v19, v238 row_ror:4 row_mask:0xf bank_mask:0x1
  v_add_f32_dpp v239, v23, v239 row_ror:4 row_mask:0xf bank_mask:0x1
  v_add_f32_dpp v240, v27, v240 row_ror:4 row_mask:0xf bank_mask:0x1
  v_mfma_f32_16x16x32_bf16 v[52:55], v[52:55], v[232:235], 0
  v_add_f32_dpp v241, v29, v28 row_ror:12 row_mask:0xf bank_mask:0x1
  v_add_f32_dpp v242, v33, v32 row_ror:12 row_mask:0xf bank_mask:0x1
  v_add_f32_dpp v243, v37, v36 row_ror:12 row_mask:0xf bank_mask:0x1
  v_mfma_f32_16x16x32_bf16 v[56:59], v[56:59], v[232:235], 0
  v_add_f32_dpp v241, v30, v241 row_ror:8 row_mask:0xf bank_mask:0x1
  v_add_f32_dpp v242, v34, v242 row_ror:8 row_mask:0xf bank_mask:0x1
  v_add_f32_dpp v243, v38, v243 row_ror:8 row_mask:0xf bank_mask:0x1
  v_mfma_f32_16x16x32_bf16 v[60:63], v[60:63], v[232:235], 0
  v_add_f32_dpp v241, v31, v241 row_ror:4 row_mask:0xf bank_mask:0x1
  v_add_f32_dpp v242, v35, v242 row_ror:4 row_mask:0xf bank_mask:0x1
  v_add_f32_dpp v243, v39, v243 row_ror:4 row_mask:0xf bank_mask:0x1
  v_mfma_f32_16x16x32_bf16 v[64:67], v[64:67], v[232:235], 0
  v_add_f32_dpp v236, v42, v41 row_ror:12 row_mask:0xf bank_mask:0x2
  v_add_f32_dpp v237, v46, v45 row_ror:12 row_mask:0xf bank_mask:0x2
  v_add_f32_dpp v238, v50, v49 row_ror:12 row_mask:0xf bank_mask:0x2
  v_mfma_f32_16x16x32_bf16 v[68:71], v[68:71], v[232:235], 0
  v_add_f32_dpp v236, v43, v236 row_ror:8 row_mask:0xf bank_mask:0x2
  v_add_f32_dpp v237, v47, v237 row_ror:8 row_mask:0xf bank_mask:0x2
  v_add_f32_dpp v238, v51, v238 row_ror:8 row_mask:0xf bank_mask:0x2
  v_mfma_f32_16x16x32_bf16 v[72:75], v[72:75], v[232:235], 0
  v_add_f32_dpp v236, v40, v236 row_ror:4 row_mask:0xf bank_mask:0x2
  v_add_f32_dpp v237, v44, v237 row_ror:4 row_mask:0xf bank_mask:0x2
  v_add_f32_dpp v238, v48, v238 row_ror:4 row_mask:0xf bank_mask:0x2
  v_mfma_f32_16x16x32_bf16 v[76:79], v[76:79], v[232:235], 0
  v_add_f32_dpp v239, v54, v53 row_ror:12 row_mask:0xf bank_mask:0x2
  v_add_f32_dpp v240, v58, v57 row_ror:12 row_mask:0xf bank_mask:0x2
  v_add_f32_dpp v241, v62, v61 row_ror:12 row_mask:0xf bank_mask:0x2
  v_mfma_f32_16x16x32_bf16 v[80:83], v[80:83], v[232:235], 0
  v_add_f32_dpp v239, v55, v239 row_ror:8 row_mask:0xf bank_mask:0x2
  v_add_f32_dpp v240, v59, v240 row_ror:8 row_mask:0xf bank_mask:0x2
  v_add_f32_dpp v241, v63, v241 row_ror:8 row_mask:0xf bank_mask:0x2
  v_mfma_f32_16x16x32_bf16 v[84:87], v[84:87], v[232:235], 0
  v_add_f32_dpp v239, v52, v239 row_ror:4 row_mask:0xf bank_mask:0x2
  v_add_f32_dpp v240, v56, v240 row_ror:4 row_mask:0xf bank_mask:0x2
  v_add_f32_dpp v241, v60, v241 row_ror:4 row_mask:0xf bank_mask:0x2
  v_mfma_f32_16x16x32_bf16 v[88:91], v[88:91], v[232:235], 0
  v_add_f32_dpp v242, v66, v65 row_ror:12 row_mask:0xf bank_mask:0x2
  v_add_f32_dpp v243, v70, v69 row_ror:12 row_mask:0xf bank_mask:0x2
  v_add_f32_dpp v236, v75, v74 row_ror:12 row_mask:0xf bank_mask:0x4
  v_mfma_f32_16x16x32_bf16 v[92:95], v[92:95], v[232:235], 0
  v_add_f32_dpp v242, v67, v242 row_ror:8 row_mask:0xf bank_mask:0x2
  v_add_f32_dpp v243, v71, v243 row_ror:8 row_mask:0xf bank_mask:0x2
  v_add_f32_dpp v236, v72, v236 row_ror:8 row_mask:0xf bank_mask:0x4
  v_mfma_f32_16x16x32_bf16 v[96:99], v[96:99], v[232:235], 0
  v_add_f32_dpp v242, v64, v242 row_ror:4 row_mask:0xf bank_mask:0x2
  v_add_f32_dpp v243, v68, v243 row_ror:4 row_mask:0xf bank_mask:0x2
  v_add_f32_dpp v236, v73, v236 row_ror:4 row_mask:0xf bank_mask:0x4
  v_mfma_f32_16x16x32_bf16 v[100:103], v[100:103], v[232:235], 0
  v_add_f32_dpp v237, v79, v78 row_ror:12 row_mask:0xf bank_mask:0x4
  v_add_f32_dpp v238, v83, v82 row_ror:12 row_mask:0xf bank_mask:0x4
  v_add_f32_dpp v239, v87, v86 row_ror:12 row_mask:0xf bank_mask:0x4
  v_add_f32_dpp v237, v76, v237 row_ror:8 row_mask:0xf bank_mask:0x4
  v_add_f32_dpp v238, v80, v238 row_ror:8 row_mask:0xf bank_mask:0x4
  v_add_f32_dpp v239, v84, v239 row_ror:8 row_mask:0xf bank_mask:0x4
  v_add_f32_dpp v237, v77, v237 row_ror:4 row_mask:0xf bank_mask:0x4
  v_add_f32_dpp v238, v81, v238 row_ror:4 row_mask:0xf bank_mask:0x4
  v_add_f32_dpp v239, v85, v239 row_ror:4 row_mask:0xf bank_mask:0x4
  v_add_f32_dpp v240, v91, v90 row_ror:12 row_mask:0xf bank_mask:0x4
  v_add_f32_dpp v241, v95, v94 row_ror:12 row_mask:0xf bank_mask:0x4
  v_add_f32_dpp v242, v99, v98 row_ror:12 row_mask:0xf bank_mask:0x4
  v_add_f32_dpp v240, v88, v240 row_ror:8 row_mask:0xf bank_mask:0x4
  v_add_f32_dpp v241, v92, v241 row_ror:8 row_mask:0xf bank_mask:0x4
  v_add_f32_dpp v242, v96, v242 row_ror:8 row_mask:0xf bank_mask:0x4
  v_add_f32_dpp v240, v89, v240 row_ror:4 row_mask:0xf bank_mask:0x4
  v_add_f32_dpp v241, v93, v241 row_ror:4 row_mask:0xf bank_mask:0x4
  v_add_f32_dpp v242, v97, v242 row_ror:4 row_mask:0xf bank_mask:0x4
  v_add_f32_dpp v243, v103, v102 row_ror:12 row_mask:0xf bank_mask:0x4
  s_nop 1
  v_add_f32_dpp v243, v100, v243 row_ror:8 row_mask:0xf bank_mask:0x4
  s_nop 1
  v_add_f32_dpp v243, v101, v243 row_ror:4 row_mask:0xf bank_mask:0x4
  v_cvt_pk_bf16_f32 v84, v236, v237
  v_lshlrev_b32 v236, 16, v84
  v_and_b32 v237, 0xffff0000, v84
  v_cvt_pk_bf16_f32 v85, v238, v239
  v_lshlrev_b32 v238, 16, v85
  v_and_b32 v239, 0xffff0000, v85
  v_cvt_pk_bf16_f32 v86, v240, v241
  v_lshlrev_b32 v240, 16, v86
  v_and_b32 v241, 0xffff0000, v86
  v_cvt_pk_bf16_f32 v87, v242, v243
  v_lshlrev_b32 v242, 16, v87
  v_and_b32 v243, 0xffff0000, v87
  v_mul_f32 v236, s29, v236
  v_mul_f32 v237, s29, v237
  v_mul_f32 v238, s29, v238
  v_mul_f32 v239, s29, v239
  v_mul_f32 v240, s29, v240
  v_mul_f32 v241, s29, v241
  v_mul_f32 v242, s29, v242
  v_mul_f32 v243, s29, v243
  v_cvt_pk_bf16_f32 v84, v236, v237
  v_lshlrev_b32 v236, 16, v84
  v_and_b32 v237, 0xffff0000, v84
  v_cvt_pk_bf16_f32 v85, v238, v239
  v_lshlrev_b32 v238, 16, v85
  v_and_b32 v239, 0xffff0000, v85
  v_cvt_pk_bf16_f32 v86, v240, v241
  v_lshlrev_b32 v240, 16, v86
  v_and_b32 v241, 0xffff0000, v86
  v_cvt_pk_bf16_f32 v87, v242, v243
  v_lshlrev_b32 v242, 16, v87
  v_and_b32 v243, 0xffff0000, v87
  v_max_f32 v88, v236, v237
  v_max3_f32 v88, v88, v238, v239
  v_max3_f32 v88, v88, v240, v241
  v_max3_f32 v88, v88, v242, v243
  s_nop 1
  v_max_f32_dpp v88, v88, v88 row_ror:4 row_mask:0xf bank_mask:0xf
  s_nop 1
  v_max_f32_dpp v88, v88, v88 row_ror:8 row_mask:0xf bank_mask:0xf
  v_mov_b32 v84, v88
  s_nop 1
  v_permlane16_swap_b32 v88, v84
  v_max_f32 v88, v88, v84
  v_mov_b32 v84, v88
  s_nop 1
  v_permlane32_swap_b32 v88, v84
  v_max_f32 v88, v88, v84
  v_mul_f32 v90, s30, v88
  v_fma_f32 v236, v236, s30, -v90
  v_fma_f32 v237, v237, s30, -v90
  v_fma_f32 v238, v238, s30, -v90
  v_fma_f32 v239, v239, s30, -v90
  v_fma_f32 v240, v240, s30, -v90
  v_fma_f32 v241, v241, s30, -v90
  v_fma_f32 v242, v242, s30, -v90
  v_fma_f32 v243, v243, s30, -v90
  v_exp_f32 v236, v236
  v_exp_f32 v237, v237
  v_exp_f32 v238, v238
  v_exp_f32 v239, v239
  v_exp_f32 v240, v240
  v_exp_f32 v241, v241
  v_exp_f32 v242, v242
  v_exp_f32 v243, v243
  v_add_f32 v89, v236, v237
  v_add_f32 v89, v89, v238
  v_add_f32 v89, v89, v239
  v_add_f32 v89, v89, v240
  v_add_f32 v89, v89, v241
  v_add_f32 v89, v89, v242
  v_add_f32 v89, v89, v243
  v_cvt_pk_bf16_f32 v236, v236, v237
  v_cvt_pk_bf16_f32 v237, v238, v239
  v_cvt_pk_bf16_f32 v238, v240, v241
  v_cvt_pk_bf16_f32 v239, v242, v243
  v_add_f32_dpp v89, v89, v89 row_ror:4 row_mask:0xf bank_mask:0xf
  s_nop 1
  v_add_f32_dpp v89, v89, v89 row_ror:8 row_mask:0xf bank_mask:0xf
  v_mov_b32 v16, 0
  v_mov_b32 v17, 0
  v_mov_b32 v18, 0
  v_mov_b32 v19, 0
  v_mov_b32 v20, 0
  v_mov_b32 v21, 0
  v_mov_b32 v22, 0
  v_mov_b32 v23, 0
  v_mov_b32 v24, 0
  v_mov_b32 v25, 0
  v_mov_b32 v26, 0
  v_mov_b32 v27, 0
  v_mov_b32 v28, 0
  v_mov_b32 v29, 0
  v_mov_b32 v30, 0
  v_mov_b32 v31, 0
  v_mov_b32_dpp v16, v236 row_ror:4 row_mask:0xf bank_mask:0x1
  v_mov_b32_dpp v17, v237 row_ror:4 row_mask:0xf bank_mask:0x1
  v_mov_b32_dpp v18, v238 row_ror:4 row_mask:0xf bank_mask:0x1
  v_mov_b32_dpp v19, v239 row_ror:4 row_mask:0xf bank_mask:0x1
  v_mov_b32_dpp v20, v236 row_ror:8 row_mask:0xf bank_mask:0x2
  v_mov_b32_dpp v21, v237 row_ror:8 row_mask:0xf bank_mask:0x2
  v_mov_b32_dpp v22, v238 row_ror:8 row_mask:0xf bank_mask:0x2
  v_mov_b32_dpp v23, v239 row_ror:8 row_mask:0xf bank_mask:0x2
  v_mov_b32_dpp v24, v236 row_ror:12 row_mask:0xf bank_mask:0x4
  v_mov_b32_dpp v25, v237 row_ror:12 row_mask:0xf bank_mask:0x4
  v_mov_b32_dpp v26, v238 row_ror:12 row_mask:0xf bank_mask:0x4
  v_mov_b32_dpp v27, v239 row_ror:12 row_mask:0xf bank_mask:0x4
  v_mov_b32_dpp v28, v236 quad_perm:[0,1,2,3] row_mask:0xf bank_mask:0x8
  v_mov_b32_dpp v29, v237 quad_perm:[0,1,2,3] row_mask:0xf bank_mask:0x8
  v_mov_b32_dpp v30, v238 quad_perm:[0,1,2,3] row_mask:0xf bank_mask:0x8
  v_mov_b32_dpp v31, v239 quad_perm:[0,1,2,3] row_mask:0xf bank_mask:0x8
  v_perm_b32 v72, v220, v216, s27
  v_perm_b32 v73, v228, v224, s27
  v_perm_b32 v74, v220, v216, s27
  v_perm_b32 v75, v228, v224, s27
  v_perm_b32 v76, v220, v216, s28
  v_perm_b32 v77, v228, v224, s28
  v_perm_b32 v78, v220, v216, s28
  v_perm_b32 v79, v228, v224, s28
  v_mfma_f32_16x16x32_bf16 v[8:11], v[72:75], v[16:19], 0
  v_perm_b32 v80, v221, v217, s27
  v_perm_b32 v81, v229, v225, s27
  v_perm_b32 v82, v221, v217, s27
  v_perm_b32 v83, v229, v225, s27
  v_mfma_f32_16x16x32_bf16 v[8:11], v[76:79], v[20:23], v[8:11]
  v_perm_b32 v72, v221, v217, s28
  v_perm_b32 v73, v229, v225, s28
  v_perm_b32 v74, v221, v217, s28
  v_perm_b32 v75, v229, v225, s28
  v_mfma_f32_16x16x32_bf16 v[8:11], v[80:83], v[24:27], v[8:11]
  v_perm_b32 v76, v222, v218, s27
  v_perm_b32 v77, v230, v226, s27
  v_perm_b32 v78, v222, v218, s27
  v_perm_b32 v79, v230, v226, s27
  v_mfma_f32_16x16x32_bf16 v[8:11], v[72:75], v[28:31], v[8:11]
  v_perm_b32 v80, v222, v218, s28
  v_perm_b32 v81, v230, v226, s28
  v_perm_b32 v82, v222, v218, s28
  v_perm_b32 v83, v230, v226, s28
  v_mfma_f32_16x16x32_bf16 v[12:15], v[76:79], v[16:19], 0
  v_perm_b32 v72, v223, v219, s27
  v_perm_b32 v73, v231, v227, s27
  v_perm_b32 v74, v223, v219, s27
  v_perm_b32 v75, v231, v227, s27
  v_mfma_f32_16x16x32_bf16 v[12:15], v[80:83], v[20:23], v[12:15]
  v_perm_b32 v76, v223, v219, s28
  v_perm_b32 v77, v231, v227, s28
  v_perm_b32 v78, v223, v219, s28
  v_perm_b32 v79, v231, v227, s28
  v_mfma_f32_16x16x32_bf16 v[12:15], v[72:75], v[24:27], v[12:15]
  s_nop 0
  v_mfma_f32_16x16x32_bf16 v[12:15], v[76:79], v[28:31], v[12:15]
  s_cmp_eq_u32 s77, 0
  s_cbranch_scc1 L_nv9
  buffer_load_dwordx4 v[216:219], v3, s[8:11], s22 offen offset:0 nt
  buffer_load_dwordx4 v[220:223], v3, s[8:11], s22 offen offset:1024 nt
  buffer_load_dwordx4 v[224:227], v3, s[8:11], s22 offen offset:2048 nt
  buffer_load_dwordx4 v[228:231], v3, s[8:11], s22 offen offset:3072 nt
L_nv9:
  v_mov_b32_dpp v16, v236 quad_perm:[0,1,2,3] row_mask:0xf bank_mask:0x1
  v_mov_b32_dpp v17, v237 quad_perm:[0,1,2,3] row_mask:0xf bank_mask:0x1
  v_mov_b32_dpp v18, v238 quad_perm:[0,1,2,3] row_mask:0xf bank_mask:0x1
  v_mov_b32_dpp v19, v239 quad_perm:[0,1,2,3] row_mask:0xf bank_mask:0x1
  v_mov_b32_dpp v20, v236 row_ror:4 row_mask:0xf bank_mask:0x2
  v_mov_b32_dpp v21, v237 row_ror:4 row_mask:0xf bank_mask:0x2
  v_mov_b32_dpp v22, v238 row_ror:4 row_mask:0xf bank_mask:0x2
  v_mov_b32_dpp v23, v239 row_ror:4 row_mask:0xf bank_mask:0x2
  v_mov_b32_dpp v24, v236 row_ror:8 row_mask:0xf bank_mask:0x4
  v_mov_b32_dpp v25, v237 row_ror:8 row_mask:0xf bank_mask:0x4
  v_mov_b32_dpp v26, v238 row_ror:8 row_mask:0xf bank_mask:0x4
  v_mov_b32_dpp v27, v239 row_ror:8 row_mask:0xf bank_mask:0x4
  v_mov_b32_dpp v28, v236 row_ror:12 row_mask:0xf bank_mask:0x8
  v_mov_b32_dpp v29, v237 row_ror:12 row_mask:0xf bank_mask:0x8
  v_mov_b32_dpp v30, v238 row_ror:12 row_mask:0xf bank_mask:0x8
  v_mov_b32_dpp v31, v239 row_ror:12 row_mask:0xf bank_mask:0x8
  v_perm_b32 v72, v108, v104, s27
  v_perm_b32 v73, v116, v112, s27
  v_perm_b32 v74, v124, v120, s27
  v_perm_b32 v75, v132, v128, s27
  v_perm_b32 v76, v108, v104, s28
  v_perm_b32 v77, v116, v112, s28
  v_perm_b32 v78, v124, v120, s28
  v_perm_b32 v79, v132, v128, s28
  v_mfma_f32_16x16x32_bf16 v[8:11], v[72:75], v[16:19], v[8:11]
  v_perm_b32 v80, v109, v105, s27
  v_perm_b32 v81, v117, v113, s27
  v_perm_b32 v82, v125, v121, s27
  v_perm_b32 v83, v133, v129, s27
  v_mfma_f32_16x16x32_bf16 v[8:11], v[76:79], v[20:23], v[8:11]
  v_perm_b32 v72, v109, v105, s28
  v_perm_b32 v73, v117, v113, s28
  v_perm_b32 v74, v125, v121, s28
  v_perm_b32 v75, v133, v129, s28
  v_mfma_f32_16x16x32_bf16 v[8:11], v[80:83], v[24:27], v[8:11]
  v_perm_b32 v76, v110, v106, s27
  v_perm_b32 v77, v118, v114, s27
  v_perm_b32 v78, v126, v122, s27
  v_perm_b32 v79, v134, v130, s27
  v_mfma_f32_16x16x32_bf16 v[8:11], v[72:75], v[28:31], v[8:11]
  v_perm_b32 v80, v110, v106, s28
  v_perm_b32 v81, v118, v114, s28
  v_perm_b32 v82, v126, v122, s28
  v_perm_b32 v83, v134, v130, s28
  v_mfma_f32_16x16x32_bf16 v[12:15], v[76:79], v[16:19], v[12:15]
  v_perm_b32 v72, v111, v107, s27
  v_perm_b32 v73, v119, v115, s27
  v_perm_b32 v74, v127, v123, s27
  v_perm_b32 v75, v135, v131, s27
  v_mfma_f32_16x16x32_bf16 v[12:15], v[80:83], v[20:23], v[12:15]
  v_perm_b32 v76, v111, v107, s28
  v_perm_b32 v77, v119, v115, s28
  v_perm_b32 v78, v127, v123, s28
  v_perm_b32 v79, v135, v131, s28
  v_mfma_f32_16x16x32_bf16 v[12:15], v[72:75], v[24:27], v[12:15]
  s_nop 0
  v_mfma_f32_16x16x32_bf16 v[12:15], v[76:79], v[28:31], v[12:15]
  v_mov_b32_dpp v16, v236 row_ror:12 row_mask:0xf bank_mask:0x1
  v_mov_b32_dpp v17, v237 row_ror:12 row_mask:0xf bank_mask:0x1
  v_mov_b32_dpp v18, v238 row_ror:12 row_mask:0xf bank_mask:0x1
  v_mov_b32_dpp v19, v239 row_ror:12 row_mask:0xf bank_mask:0x1
  v_mov_b32_dpp v20, v236 quad_perm:[0,1,2,3] row_mask:0xf bank_mask:0x2
  v_mov_b32_dpp v21, v237 quad_perm:[0,1,2,3] row_mask:0xf bank_mask:0x2
  v_mov_b32_dpp v22, v238 quad_perm:[0,1,2,3] row_mask:0xf bank_mask:0x2
  v_mov_b32_dpp v23, v239 quad_perm:[0,1,2,3] row_mask:0xf bank_mask:0x2
  v_mov_b32_dpp v24, v236 row_ror:4 row_mask:0xf bank_mask:0x4
  v_mov_b32_dpp v25, v237 row_ror:4 row_mask:0xf bank_mask:0x4
  v_mov_b32_dpp v26, v238 row_ror:4 row_mask:0xf bank_mask:0x4
  v_mov_b32_dpp v27, v239 row_ror:4 row_mask:0xf bank_mask:0x4
  v_mov_b32_dpp v28, v236 row_ror:8 row_mask:0xf bank_mask:0x8
  v_mov_b32_dpp v29, v237 row_ror:8 row_mask:0xf bank_mask:0x8
  v_mov_b32_dpp v30, v238 row_ror:8 row_mask:0xf bank_mask:0x8
  v_mov_b32_dpp v31, v239 row_ror:8 row_mask:0xf bank_mask:0x8
  v_perm_b32 v72, v140, v136, s27
  v_perm_b32 v73, v148, v144, s27
  v_perm_b32 v74, v156, v152, s27
  v_perm_b32 v75, v164, v160, s27
  v_perm_b32 v76, v140, v136, s28
  v_perm_b32 v77, v148, v144, s28
  v_perm_b32 v78, v156, v152, s28
  v_perm_b32 v79, v164, v160, s28
  v_mfma_f32_16x16x32_bf16 v[8:11], v[72:75], v[16:19], v[8:11]
  v_perm_b32 v80, v141, v137, s27
  v_perm_b32 v81, v149, v145, s27
  v_perm_b32 v82, v157, v153, s27
  v_perm_b32 v83, v165, v161, s27
  v_mfma_f32_16x16x32_bf16 v[8:11], v[76:79], v[20:23], v[8:11]
  v_perm_b32 v72, v141, v137, s28
  v_perm_b32 v73, v149, v145, s28
  v_perm_b32 v74, v157, v153, s28
  v_perm_b32 v75, v165, v161, s28
  v_mfma_f32_16x16x32_bf16 v[8:11], v[80:83], v[24:27], v[8:11]
  v_perm_b32 v76, v142, v138, s27
  v_perm_b32 v77, v150, v146, s27
  v_perm_b32 v78, v158, v154, s27
  v_perm_b32 v79, v166, v162, s27
  v_mfma_f32_16x16x32_bf16 v[8:11], v[72:75], v[28:31], v[8:11]
  v_perm_b32 v80, v142, v138, s28
  v_perm_b32 v81, v150, v146, s28
  v_perm_b32 v82, v158, v154, s28
  v_perm_b32 v83, v166, v162, s28
  v_mfma_f32_16x16x32_bf16 v[12:15], v[76:79], v[16:19], v[12:15]
  v_perm_b32 v72, v143, v139, s27
  v_perm_b32 v73, v151, v147, s27
  v_perm_b32 v74, v159, v155, s27
  v_perm_b32 v75, v167, v163, s27
  v_mfma_f32_16x16x32_bf16 v[12:15], v[80:83], v[20:23], v[12:15]
  v_perm_b32 v76, v143, v139, s28
  v_perm_b32 v77, v151, v147, s28
  v_perm_b32 v78, v159, v155, s28
  v_perm_b32 v79, v167, v163, s28
  v_mfma_f32_16x16x32_bf16 v[12:15], v[72:75], v[24:27], v[12:15]
  s_nop 0
  v_mfma_f32_16x16x32_bf16 v[12:15], v[76:79], v[28:31], v[12:15]
  s_waitcnt vmcnt(9)
  s_cmp_eq_u32 s77, 1
  s_cbranch_scc1 L_nj10
  s_waitcnt vmcnt(0)
L_nj10:
  v_mov_b32_dpp v16, v236 row_ror:8 row_mask:0xf bank_mask:0x1
  v_mov_b32_dpp v17, v237 row_ror:8 row_mask:0xf bank_mask:0x1
  v_mov_b32_dpp v18, v238 row_ror:8 row_mask:0xf bank_mask:0x1
  v_mov_b32_dpp v19, v239 row_ror:8 row_mask:0xf bank_mask:0x1
  v_mov_b32_dpp v20, v236 row_ror:12 row_mask:0xf bank_mask:0x2
  v_mov_b32_dpp v21, v237 row_ror:12 row_mask:0xf bank_mask:0x2
  v_mov_b32_dpp v22, v238 row_ror:12 row_mask:0xf bank_mask:0x2
  v_mov_b32_dpp v23, v239 row_ror:12 row_mask:0xf bank_mask:0x2
  v_mov_b32_dpp v24, v236 quad_perm:[0,1,2,3] row_mask:0xf bank_mask:0x4
  v_mov_b32_dpp v25, v237 quad_perm:[0,1,2,3] row_mask:0xf bank_mask:0x4
  v_mov_b32_dpp v26, v238 quad_perm:[0,1,2,3] row_mask:0xf bank_mask:0x4
  v_mov_b32_dpp v27, v239 quad_perm:[0,1,2,3] row_mask:0xf bank_mask:0x4
  v_mov_b32_dpp v28, v236 row_ror:4 row_mask:0xf bank_mask:0x8
  v_mov_b32_dpp v29, v237 row_ror:4 row_mask:0xf bank_mask:0x8
  v_mov_b32_dpp v30, v238 row_ror:4 row_mask:0xf bank_mask:0x8
  v_mov_b32_dpp v31, v239 row_ror:4 row_mask:0xf bank_mask:0x8
  v_perm_b32 v72, v172, v168, s27
  v_perm_b32 v73, v180, v176, s27
  v_perm_b32 v74, v188, v184, s27
  v_perm_b32 v75, v196, v192, s27
  v_perm_b32 v76, v172, v168, s28
  v_perm_b32 v77, v180, v176, s28
  v_perm_b32 v78, v188, v184, s28
  v_perm_b32 v79, v196, v192, s28
  v_mfma_f32_16x16x32_bf16 v[8:11], v[72:75], v[16:19], v[8:11]
  v_perm_b32 v80, v173, v169, s27
  v_perm_b32 v81, v181, v177, s27
  v_perm_b32 v82, v189, v185, s27
  v_perm_b32 v83, v197, v193, s27
  v_mfma_f32_16x16x32_bf16 v[8:11], v[76:79], v[20:23], v[8:11]
  v_perm_b32 v72, v173, v169, s28
  v_perm_b32 v73, v181, v177, s28
  v_perm_b32 v74, v189, v185, s28
  v_perm_b32 v75, v197, v193, s28
  v_mfma_f32_16x16x32_bf16 v[8:11], v[80:83], v[24:27], v[8:11]
  v_perm_b32 v76, v174, v170, s27
  v_perm_b32 v77, v182, v178, s27
  v_perm_b32 v78, v190, v186, s27
  v_perm_b32 v79, v198, v194, s27
  v_mfma_f32_16x16x32_bf16 v[8:11], v[72:75], v[28:31], v[8:11]
  v_perm_b32 v80, v174, v170, s28
  v_perm_b32 v81, v182, v178, s28
  v_perm_b32 v82, v190, v186, s28
  v_perm_b32 v83, v198, v194, s28
  v_mfma_f32_16x16x32_bf16 v[12:15], v[76:79], v[16:19], v[12:15]
  v_perm_b32 v72, v175, v171, s27
  v_perm_b32 v73, v183, v179, s27
  v_perm_b32 v74, v191, v187, s27
  v_perm_b32 v75, v199, v195, s27
  v_mfma_f32_16x16x32_bf16 v[12:15], v[80:83], v[20:23], v[12:15]
  v_perm_b32 v76, v175, v171, s28
  v_perm_b32 v77, v183, v179, s28
  v_perm_b32 v78, v191, v187, s28
  v_perm_b32 v79, v199, v195, s28
  v_mfma_f32_16x16x32_bf16 v[12:15], v[72:75], v[24:27], v[12:15]
  s_nop 0
  v_mfma_f32_16x16x32_bf16 v[12:15], v[76:79], v[28:31], v[12:15]
  s_mov_b32 s32, 0x000f000f
  s_mov_b32 s33, 0x000f000f
  v_mov_b32 v18, 0
  v_mov_b32 v22, 0
  v_mov_b32 v26, 0
  v_mov_b32 v30, 0
  v_mov_b32 v42, 0
  v_mov_b32 v46, 0
  v_mov_b32 v50, 0
  v_mov_b32 v54, 0
  v_mov_b32 v58, 0
  v_mov_b32 v62, 0
  v_mov_b32 v66, 0
  v_mov_b32 v70, 0
  v_mov_b32 v19, 0
  v_mov_b32 v23, 0
  v_mov_b32 v27, 0
  v_mov_b32 v31, 0
  v_mov_b32 v43, 0
  v_mov_b32 v47, 0
  v_mov_b32 v51, 0
  v_mov_b32 v55, 0
  v_mov_b32 v59, 0
  v_mov_b32 v63, 0
  v_mov_b32 v67, 0
  v_mov_b32 v71, 0
  s_mul_i32 s24, s3, 2112
  v_mul_u32_u24 v93, 528, v4
  v_and_b32 v94, 48, v1
  v_add3_u32 v93, v93, v94, s24
  v_and_b32 v94, 12, v1
  v_lshl_add_u32 v93, v94, 4, v93
  s_lshl_b32 s24, s3, 5
  s_add_u32 s24, s24, 16896
  v_lshl_add_u32 v96, v4, 3, s24
  s_lshr_b32 s66, s3, 1
  s_lshl_b32 s24, s66, 3
  s_add_u32 s24, s24, 16896
  v_and_b32 v97, 7, v1
  v_lshl_add_u32 v97, v97, 5, s24
  s_lshl_b32 s67, s26, 2
  s_add_u32 s67, s67, s66
  s_mul_i32 s67, s67, 40960
  s_add_u32 s67, s67, 131072
  s_mul_i32 s24, s66, 528
  s_and_b32 s76, s3, 1
  s_lshl_b32 s76, s76, 8
  s_add_u32 s24, s24, s76
  v_lshl_add_u32 v94, v1, 2, s24
  v_lshlrev_b32 v95, 2, v1
  s_lshl_b32 s24, s25, 3
  s_add_u32 s24, s24, s21
  s_lshl_b32 s24, s24, 9
  s_add_u32 s24, s24, s76
  s_add_u32 s80, s24, s67
  s_lshr_b32 s24, s24, 1
  s_add_u32 s79, s24, s67
  s_add_u32 s79, s79, 16384
  v_mov_b32 v100, 0
  v_mov_b32 v101, 1
  s_cmp_eq_u32 s77, 0
  s_cbranch_scc1 L_att_none
L_att_loop:
  s_waitcnt vmcnt(5)
  v_mfma_f32_16x16x32_bf16 v[200:203], v[200:203], v[232:235], 0
  v_mfma_f32_16x16x32_bf16 v[204:207], v[204:207], v[232:235], 0
  v_mfma_f32_16x16x32_bf16 v[208:211], v[208:211], v[232:235], 0
  v_mfma_f32_16x16x32_bf16 v[212:215], v[212:215], v[232:235], 0
  s_nop 4
  v_add_f32_dpp v244, v201, v200 row_ror:12 row_mask:0xf bank_mask:0x1
  v_add_f32_dpp v245, v205, v204 row_ror:12 row_mask:0xf bank_mask:0x1
  v_add_f32_dpp v246, v209, v208 row_ror:12 row_mask:0xf bank_mask:0x1
  v_add_f32_dpp v247, v213, v212 row_ror:12 row_mask:0xf bank_mask:0x1
  v_add_f32_dpp v244, v202, v244 row_ror:8 row_mask:0xf bank_mask:0x1
  v_add_f32_dpp v245, v206, v245 row_ror:8 row_mask:0xf bank_mask:0x1
  v_add_f32_dpp v246, v210, v246 row_ror:8 row_mask:0xf bank_mask:0x1
  v_add_f32_dpp v247, v214, v247 row_ror:8 row_mask:0xf bank_mask:0x1
  v_add_f32_dpp v244, v203, v244 row_ror:4 row_mask:0xf bank_mask:0x1
  v_add_f32_dpp v245, v207, v245 row_ror:4 row_mask:0xf bank_mask:0x1
  v_add_f32_dpp v246, v211, v246 row_ror:4 row_mask:0xf bank_mask:0x1
  v_add_f32_dpp v247, v215, v247 row_ror:4 row_mask:0xf bank_mask:0x1
  v_cvt_pk_bf16_f32 v84, v244, v245
  v_lshlrev_b32 v244, 16, v84
  v_and_b32 v245, 0xffff0000, v84
  v_cvt_pk_bf16_f32 v85, v246, v247
  v_lshlrev_b32 v246, 16, v85
  v_and_b32 v247, 0xffff0000, v85
  v_mul_f32 v244, s29, v244
  v_mul_f32 v245, s29, v245
  v_mul_f32 v246, s29, v246
  v_mul_f32 v247, s29, v247
  v_cvt_pk_bf16_f32 v84, v244, v245
  v_lshlrev_b32 v244, 16, v84
  v_and_b32 v245, 0xffff0000, v84
  v_cvt_pk_bf16_f32 v85, v246, v247
  v_lshlrev_b32 v246, 16, v85
  v_and_b32 v247, 0xffff0000, v85
  v_max3_f32 v91, v88, v244, v245
  v_max3_f32 v91, v91, v246, v247
  v_mov_b32 v84, v91
  s_nop 1
  v_permlane16_swap_b32 v91, v84
  v_max_f32 v91, v91, v84
  v_mov_b32 v84, v91
  s_nop 1
  v_permlane32_swap_b32 v91, v84
  v_max_f32 v91, v91, v84
  v_cmp_neq_f32 vcc, v88, v91
  v_mul_f32 v90, s30, v91
  s_and_b64 vcc, vcc, s[32:33]
  s_cbranch_scc0 L_keep11
  v_sub_f32 v92, v88, v91
  v_mul_f32 v92, s30, v92
  v_exp_f32 v92, v92
  v_mov_b32 v88, v91
  v_mul_f32 v89, v89, v92
  v_mov_b32_dpp v92, v92 row_ror:4 row_mask:0xf bank_mask:0x2
  s_nop 1
  v_mov_b32_dpp v92, v92 row_ror:8 row_mask:0xf bank_mask:0xc
  v_mul_f32 v8, v8, v92
  v_mul_f32 v9, v9, v92
  v_mul_f32 v10, v10, v92
  v_mul_f32 v11, v11, v92
  v_mul_f32 v12, v12, v92
  v_mul_f32 v13, v13, v92
  v_mul_f32 v14, v14, v92
  v_mul_f32 v15, v15, v92
L_keep11:
  v_fma_f32 v244, v244, s30, -v90
  v_fma_f32 v245, v245, s30, -v90
  v_fma_f32 v246, v246, s30, -v90
  v_fma_f32 v247, v247, s30, -v90
  v_exp_f32 v244, v244
  v_exp_f32 v245, v245
  v_exp_f32 v246, v246
  v_exp_f32 v247, v247
  v_cvt_pk_bf16_f32 v248, v244, v245
  v_cvt_pk_bf16_f32 v249, v246, v247
  v_add_f32 v89, v89, v244
  v_add_f32 v89, v89, v245
  v_add_f32 v89, v89, v246
  v_add_f32 v89, v89, v247
  v_mov_b32_dpp v16, v248 quad_perm:[0,1,2,3] row_mask:0xf bank_mask:0x1
  v_mov_b32_dpp v17, v249 quad_perm:[0,1,2,3] row_mask:0xf bank_mask:0x1
  v_mov_b32_dpp v20, v248 row_ror:4 row_mask:0xf bank_mask:0x2
  v_mov_b32_dpp v21, v249 row_ror:4 row_mask:0xf bank_mask:0x2
  v_mov_b32_dpp v24, v248 row_ror:8 row_mask:0xf bank_mask:0x4
  v_mov_b32_dpp v25, v249 row_ror:8 row_mask:0xf bank_mask:0x4
  v_mov_b32_dpp v28, v248 row_ror:12 row_mask:0xf bank_mask:0x8
  v_mov_b32_dpp v29, v249 row_ror:12 row_mask:0xf bank_mask:0x8
  s_waitcnt vmcnt(4)
  v_readfirstlane_b32 s22, v253
  s_nop 0
  s_add_u32 s22, s22, 9
  s_cmp_ge_u32 s22, 176
  s_cbranch_scc1 L_att_last
  s_mul_i32 s22, s22, 4096
  s_add_u32 s22, s22, 1376256
  s_waitcnt vmcnt(6)
  buffer_load_dwordx4 v[200:203], v2, s[4:7], s22 offen offset:0 nt
  s_waitcnt vmcnt(6)
  buffer_load_dwordx4 v[204:207], v2, s[4:7], s22 offen offset:1024 nt
  s_waitcnt vmcnt(6)
  buffer_load_dwordx4 v[208:211], v2, s[4:7], s22 offen offset:2048 nt
  s_waitcnt vmcnt(6)
  buffer_load_dwordx4 v[212:215], v2, s[4:7], s22 offen offset:3072 nt
  s_cmp_ge_u32 s22, s91
  s_cbranch_scc1 L_cs12
  v_mov_b32 v253, 1
  s_mov_b64 exec, 1
  buffer_atomic_add v253, off, s[12:15], s64 sc0 sc1
  s_mov_b64 exec, -1
  s_branch L_cd13
L_cs12:
  v_mov_b32 v253, 0x10000
  buffer_load_dword v252, off, s[16:19], 0
L_cd13:
  s_waitcnt vmcnt(7)
  v_perm_b32 v40, v220, v216, s27
  v_perm_b32 v56, v222, v218, s27
  v_perm_b32 v44, v220, v216, s28
  v_perm_b32 v60, v222, v218, s28
  v_perm_b32 v48, v221, v217, s27
  v_perm_b32 v64, v223, v219, s27
  v_perm_b32 v52, v221, v217, s28
  v_perm_b32 v68, v223, v219, s28
  s_waitcnt vmcnt(5)
  v_perm_b32 v41, v228, v224, s27
  v_perm_b32 v57, v230, v226, s27
  v_perm_b32 v45, v228, v224, s28
  v_mfma_f32_16x16x32_bf16 v[8:11], v[40:43], v[16:19], v[8:11]
  v_perm_b32 v61, v230, v226, s28
  v_mfma_f32_16x16x32_bf16 v[12:15], v[56:59], v[16:19], v[12:15]
  v_perm_b32 v49, v229, v225, s27
  v_mfma_f32_16x16x32_bf16 v[8:11], v[44:47], v[20:23], v[8:11]
  v_perm_b32 v65, v231, v227, s27
  v_mfma_f32_16x16x32_bf16 v[12:15], v[60:63], v[20:23], v[12:15]
  v_perm_b32 v53, v229, v225, s28
  v_mfma_f32_16x16x32_bf16 v[8:11], v[48:51], v[24:27], v[8:11]
  v_perm_b32 v69, v231, v227, s28
  v_mfma_f32_16x16x32_bf16 v[12:15], v[64:67], v[24:27], v[12:15]
  v_mfma_f32_16x16x32_bf16 v[8:11], v[52:55], v[28:31], v[8:11]
  v_mfma_f32_16x16x32_bf16 v[12:15], v[68:71], v[28:31], v[12:15]
  s_waitcnt vmcnt(6)
  buffer_load_dwordx4 v[216:219], v3, s[8:11], s22 offen offset:0 nt
  s_waitcnt vmcnt(6)
  buffer_load_dwordx4 v[220:223], v3, s[8:11], s22 offen offset:1024 nt
  s_waitcnt vmcnt(6)
  buffer_load_dwordx4 v[224:227], v3, s[8:11], s22 offen offset:2048 nt
  s_waitcnt vmcnt(6)
  buffer_load_dwordx4 v[228:231], v3, s[8:11], s22 offen offset:3072 nt
  s_branch L_att_loop
L_att_none:
  v_mov_b32 v84, v89
  s_nop 1
  v_permlane16_swap_b32 v89, v84
  v_add_f32 v89, v89, v84
  v_mov_b32 v84, v89
  s_nop 1
  v_permlane32_swap_b32 v89, v84
  v_add_f32 v89, v89, v84
  v_mul_f32 v88, s30, v88
  v_max_f32 v88, 0xff7fffff, v88
  s_mov_b64 exec, 15
  ds_write_b64 v96, v[88:89]
  s_mov_b64 exec, 1
  ds_add_rtn_u32 v91, v100, v101 offset:26616
  s_mov_b64 exec, -1
  s_branch L_att_fin
L_att_last:
  v_mov_b32 v84, v89
  s_nop 1
  v_permlane16_swap_b32 v89, v84
  v_add_f32 v89, v89, v84
  v_mov_b32 v84, v89
  s_nop 1
  v_permlane32_swap_b32 v89, v84
  v_add_f32 v89, v89, v84
  v_mul_f32 v88, s30, v88
  v_max_f32 v88, 0xff7fffff, v88
  s_mov_b64 exec, 15
  ds_write_b64 v96, v[88:89]
  s_mov_b64 exec, 1
  ds_add_rtn_u32 v91, v100, v101 offset:26616
  s_mov_b64 exec, -1
  s_waitcnt lgkmcnt(0)
  v_readfirstlane_b32 s77, v91
  s_nop 0
  s_cmp_lt_u32 s77, 7
  s_cbranch_scc1 L_ny14
  ds_read_b64 v[98:99], v97
  s_waitcnt lgkmcnt(0)
  v_max_f32_dpp v88, v98, v98 quad_perm:[1,0,3,2] row_mask:0xf bank_mask:0xf
  s_nop 1
  v_max_f32_dpp v88, v88, v88 quad_perm:[2,3,0,1] row_mask:0xf bank_mask:0xf
  s_nop 1
  v_max_f32_dpp v88, v88, v88 row_half_mirror row_mask:0xf bank_mask:0xf
  v_sub_f32 v91, v98, v88
  v_exp_f32 v91, v91
  s_nop 0
  v_mul_f32 v89, v91, v99
  v_readlane_b32 s68, v91, 0
  v_readlane_b32 s69, v91, 1
  v_add_f32_dpp v89, v89, v89 quad_perm:[1,0,3,2] row_mask:0xf bank_mask:0xf
  v_readlane_b32 s70, v91, 2
  v_readlane_b32 s71, v91, 3
  v_readlane_b32 s72, v91, 4
  v_add_f32_dpp v89, v89, v89 quad_perm:[2,3,0,1] row_mask:0xf bank_mask:0xf
  v_readlane_b32 s73, v91, 5
  v_readlane_b32 s74, v91, 6
  v_readlane_b32 s75, v91, 7
  v_add_f32_dpp v89, v89, v89 row_half_mirror row_mask:0xf bank_mask:0xf
  s_mov_b64 exec, 1
  buffer_store_dwordx2 v[88:89], off, s[12:15], s79 sc1
  s_mov_b64 exec, -1
L_ny14:
  s_cbranch_scc0 L_w715
  s_waitcnt vmcnt(2)
L_w715:
  s_waitcnt vmcnt(3)
  v_perm_b32 v40, v220, v216, s27
  v_perm_b32 v56, v222, v218, s27
  v_perm_b32 v44, v220, v216, s28
  v_perm_b32 v60, v222, v218, s28
  v_perm_b32 v48, v221, v217, s27
  v_perm_b32 v64, v223, v219, s27
  v_perm_b32 v52, v221, v217, s28
  v_perm_b32 v68, v223, v219, s28
  s_cbranch_scc0 L_w717
  s_waitcnt vmcnt(0)
L_w717:
  s_waitcnt vmcnt(1)
  v_perm_b32 v41, v228, v224, s27
  v_perm_b32 v57, v230, v226, s27
  v_perm_b32 v45, v228, v224, s28
  v_mfma_f32_16x16x32_bf16 v[8:11], v[40:43], v[16:19], v[8:11]
  v_perm_b32 v61, v230, v226, s28
  v_mfma_f32_16x16x32_bf16 v[12:15], v[56:59], v[16:19], v[12:15]
  v_perm_b32 v49, v229, v225, s27
  v_mfma_f32_16x16x32_bf16 v[8:11], v[44:47], v[20:23], v[8:11]
  v_perm_b32 v65, v231, v227, s27
  v_mfma_f32_16x16x32_bf16 v[12:15], v[60:63], v[20:23], v[12:15]
  v_perm_b32 v53, v229, v225, s28
  v_mfma_f32_16x16x32_bf16 v[8:11], v[48:51], v[24:27], v[8:11]
  v_perm_b32 v69, v231, v227, s28
  v_mfma_f32_16x16x32_bf16 v[12:15], v[64:67], v[24:27], v[12:15]
  v_mfma_f32_16x16x32_bf16 v[8:11], v[52:55], v[28:31], v[8:11]
  v_mfma_f32_16x16x32_bf16 v[12:15], v[68:71], v[28:31], v[12:15]
L_att_fin:
  s_nop 6
  ds_write_b128 v93, v[8:11] offset:0
  ds_write_b128 v93, v[12:15] offset:256
  s_cmp_ge_u32 s77, 7
  s_cbranch_scc1 L_sd19
L_sp20:
  s_sleep 1
  ds_read_b32 v91, v100 offset:26616
  s_waitcnt lgkmcnt(0)
  v_readfirstlane_b32 s77, v91
  s_nop 0
  s_cmp_lt_u32 s77, 8
  s_cbranch_scc1 L_sp20
  ds_read_b64 v[98:99], v97
  s_waitcnt lgkmcnt(0)
  v_max_f32_dpp v88, v98, v98 quad_perm:[1,0,3,2] row_mask:0xf bank_mask:0xf
  s_nop 1
  v_max_f32_dpp v88, v88, v88 quad_perm:[2,3,0,1] row_mask:0xf bank_mask:0xf
  s_nop 1
  v_max_f32_dpp v88, v88, v88 row_half_mirror row_mask:0xf bank_mask:0xf
  v_sub_f32 v91, v98, v88
  v_exp_f32 v91, v91
  s_nop 0
  v_mul_f32 v89, v91, v99
  v_readlane_b32 s68, v91, 0
  v_readlane_b32 s69, v91, 1
  v_add_f32_dpp v89, v89, v89 quad_perm:[1,0,3,2] row_mask:0xf bank_mask:0xf
  v_readlane_b32 s70, v91, 2
  v_readlane_b32 s71, v91, 3
  v_readlane_b32 s72, v91, 4
  v_add_f32_dpp v89, v89, v89 quad_perm:[2,3,0,1] row_mask:0xf bank_mask:0xf
  v_readlane_b32 s73, v91, 5
  v_readlane_b32 s74, v91, 6
  v_readlane_b32 s75, v91, 7
  v_add_f32_dpp v89, v89, v89 row_half_mirror row_mask:0xf bank_mask:0xf
  s_mov_b64 exec, 1
  buffer_store_dwordx2 v[88:89], off, s[12:15], s79 sc1
  s_mov_b64 exec, -1
L_sd19:
  s_waitcnt lgkmcnt(0)
  s_barrier
  ds_read_b32 v72, v94 offset:0
  ds_read_b32 v73, v94 offset:2112
  ds_read_b32 v74, v94 offset:4224
  ds_read_b32 v75, v94 offset:6336
  ds_read_b32 v76, v94 offset:8448
  ds_read_b32 v77, v94 offset:10560
  ds_read_b32 v78, v94 offset:12672
  ds_read_b32 v79, v94 offset:14784
  s_waitcnt lgkmcnt(4)
  v_mul_f32 v72, s68, v72
  v_mul_f32 v73, s69, v73
  v_fmac_f32 v72, s70, v74
  v_fmac_f32 v73, s71, v75
  s_waitcnt lgkmcnt(0)
  v_fmac_f32 v72, s72, v76
  v_fmac_f32 v73, s73, v77
  v_fmac_f32 v72, s74, v78
  v_fmac_f32 v73, s75, v79
  v_add_f32 v72, v72, v73
  buffer_store_dword v72, v95, s[12:15], s80 offen sc1
  s_cmp_eq_u32 s21, 7
  s_cbranch_scc1 L_epilogue
  s_endpgm
L_qrole:
  s_sub_u32 s20, s2, 32
  v_and_b32 v2, 15, v1
  v_lshrrev_b32 v3, 4, v1
  s_lshl_b32 s29, s3, 7
  v_lshlrev_b32 v7, 10, v3
  v_lshl_add_u32 v11, v2, 3, v7
  v_lshlrev_b32 v28, 16, v3
  v_lshl_add_u32 v28, v2, 4, v28
  s_and_b32 s25, s3, 3
  s_lshl_b32 s24, s25, 10
  v_lshl_add_u32 v4, v1, 4, s24
  s_lshl_b32 s23, s3, 19
  s_lshl_b32 s24, s20, 8
  s_add_u32 s23, s23, s24
  s_movk_i32 s78, 0x2000
  v_lshrrev_b32 v10, 3, v2
  v_lshl_add_u32 v10, v3, 1, v10
  v_and_b32 v5, 7, v2
  v_lshlrev_b32 v5, 4, v5
  v_mul_u32_u24 v6, 24576, v10
  v_add_u32 v6, v6, v5
  v_and_b32 v10, 8, v2
  v_add3_u32 v5, v10, v5, v7
  v_lshlrev_b32 v5, 1, v5
  v_lshlrev_b32 v30, 3, v0
  s_lshr_b32 s98, s20, 4
  s_lshl_b32 s99, s98, 3
  s_add_u32 s99, s99, s3
  s_mul_i32 s92, s99, 196608
  s_and_b32 s24, s20, 15
  s_lshl_b32 s24, s24, 7
  s_add_u32 s92, s92, s24
  s_movk_i32 s97, 6144
  s_cmp_eq_u32 s3, 0
  s_cselect_b32 s24, 0x40000000, 0
  v_add_u32 v29, s24, v28
  s_waitcnt lgkmcnt(0)
  s_mov_b32 s4, s56
  s_mov_b32 s5, s57
  s_mov_b32 s6, 0x300000
  s_mov_b32 s7, 0x20000
  s_mov_b32 s68, s54
  s_mov_b32 s69, s55
  s_mov_b32 s70, 0x1000
  s_mov_b32 s71, 0x20000
  buffer_load_dwordx2 v[96:97], v30, s[68:71], 0 offen
  buffer_load_dwordx4 v[64:67], v6, s[4:7], s92 offen nt
  s_add_u32 s92, s92, s97
  buffer_load_dwordx4 v[68:71], v6, s[4:7], s92 offen nt
  s_add_u32 s92, s92, s97
  buffer_load_dwordx4 v[72:75], v6, s[4:7], s92 offen nt
  s_add_u32 s92, s92, s97
  buffer_load_dwordx4 v[76:79], v6, s[4:7], s92 offen nt
  s_mov_b32 s64, s36
  s_mov_b32 s65, s37
  s_mov_b32 s66, 0x1000
  s_mov_b32 s67, 0x20000
  s_mov_b32 s8, s42
  s_mov_b32 s9, s43
  s_mov_b32 s10, 0x400000
  s_mov_b32 s11, 0x20000
  buffer_load_dwordx4 v[12:15], v4, s[64:67], 0 offen
  buffer_load_dwordx2 v[98:99], v11, s[64:67], s29 offen
  s_mov_b32 s96, s23
  buffer_load_dwordx4 v[128:131], v29, s[8:11], s23 offen nt
  s_add_u32 s23, s23, s78
  buffer_load_dwordx4 v[132:135], v29, s[8:11], s23 offen nt
  s_add_u32 s23, s23, s78
  s_mov_b32 s12, s62
  s_mov_b32 s13, s63
  s_mov_b32 s14, 0x400000
  s_mov_b32 s15, 0x20000
  s_mov_b32 s16, s60
  s_mov_b32 s17, s61
  s_mov_b32 s18, 0x100
  s_mov_b32 s19, 0x20000
  s_mov_b32 s27, 0x05040100
  s_mov_b32 s28, 0x07060302
  s_mov_b32 s30, 0x3fb8aa3b
  v_and_b32 v8, 3, v1
  v_mul_u32_u24 v8, 1056, v8
  v_lshl_add_u32 v8, v3, 4, v8
  v_add_u32 v8, s29, v8
  s_lshl_b32 s24, s3, 11
  s_add_u32 s24, s24, 4352
  v_lshl_add_u32 v9, v2, 4, s24
  s_mov_b32 s93, 0x32a5705f
  s_waitcnt vmcnt(8)
  v_lshlrev_b32 v104, 16, v96
  v_and_b32 v105, 0xffff0000, v96
  v_lshlrev_b32 v106, 16, v97
  v_and_b32 v107, 0xffff0000, v97
  v_mul_f32 v108, s30, v104
  v_mul_f32 v109, s30, v105
  v_mul_f32 v110, s30, v106
  v_mul_f32 v111, s30, v107
  v_fma_f32 v112, v104, s30, -v108
  v_fma_f32 v113, v105, s30, -v109
  v_fma_f32 v114, v106, s30, -v110
  v_fma_f32 v115, v107, s30, -v111
  v_fma_f32 v112, v104, s93, v112
  v_fma_f32 v113, v105, s93, v113
  v_fma_f32 v114, v106, s93, v114
  v_fma_f32 v115, v107, s93, v115
  v_rndne_f32 v116, v108
  v_rndne_f32 v117, v109
  v_rndne_f32 v118, v110
  v_rndne_f32 v119, v111
  v_sub_f32 v108, v108, v116
  v_sub_f32 v109, v109, v117
  v_sub_f32 v110, v110, v118
  v_sub_f32 v111, v111, v119
  v_add_f32 v108, v108, v112
  v_add_f32 v109, v109, v113
  v_add_f32 v110, v110, v114
  v_add_f32 v111, v111, v115
  v_exp_f32 v108, -v108
  v_exp_f32 v109, -v109
  v_exp_f32 v110, -v110
  v_exp_f32 v111, -v111
  v_cvt_i32_f32 v116, -v116
  v_cvt_i32_f32 v117, -v117
  v_cvt_i32_f32 v118, -v118
  v_cvt_i32_f32 v119, -v119
  v_ldexp_f32 v108, v108, v116
  v_ldexp_f32 v109, v109, v117
  v_ldexp_f32 v110, v110, v118
  v_ldexp_f32 v111, v111, v119
  v_add_f32 v108, 1.0, v108
  v_add_f32 v109, 1.0, v109
  v_add_f32 v110, 1.0, v110
  v_add_f32 v111, 1.0, v111
  v_rcp_f32 v112, v108
  v_rcp_f32 v113, v109
  v_rcp_f32 v114, v110
  v_rcp_f32 v115, v111
  v_fma_f32 v116, -v108, v112, 1.0
  v_fma_f32 v117, -v109, v113, 1.0
  v_fma_f32 v118, -v110, v114, 1.0
  v_fma_f32 v119, -v111, v115, 1.0
  v_fma_f32 v112, v116, v112, v112
  v_fma_f32 v113, v117, v113, v113
  v_fma_f32 v114, v118, v114, v114
  v_fma_f32 v115, v119, v115, v115
  v_mul_f32 v116, v104, v112
  v_mul_f32 v117, v105, v113
  v_mul_f32 v118, v106, v114
  v_mul_f32 v119, v107, v115
  v_fma_f32 v120, -v108, v116, v104
  v_fma_f32 v121, -v109, v117, v105
  v_fma_f32 v122, -v110, v118, v106
  v_fma_f32 v123, -v111, v119, v107
  v_fma_f32 v116, v120, v112, v116
  v_fma_f32 v117, v121, v113, v117
  v_fma_f32 v118, v122, v114, v118
  v_fma_f32 v119, v123, v115, v119
  v_div_fixup_f32 v104, v116, v108, v104
  v_div_fixup_f32 v105, v117, v109, v105
  v_div_fixup_f32 v106, v118, v110, v106
  v_div_fixup_f32 v107, v119, v111, v107
  v_cvt_pk_bf16_f32 v96, v104, v105
  v_cvt_pk_bf16_f32 v97, v106, v107
  v_lshrrev_b32 v124, 7, v0
  v_lshl_add_u32 v124, v124, 5, v30
  ds_write_b64 v124, v[96:97] offset:0
  v_lshrrev_b32 v127, 5, v1
  v_lshlrev_b32 v127, 3, v127
  v_add_u32 v127, 128, v127
  s_cmp_eq_u32 s3, 0
  s_cselect_b32 s24, 0, 0x40000000
  v_add_u32 v123, s24, v127
  buffer_load_dword v125, v123, s[16:19], 0 offen sc1
  s_lshl_b32 s24, s99, 6
  s_sub_u32 s24, s24, s29
  v_add_u32 v126, s24, v8
  v_lshlrev_b32 v10, 4, v2
  v_lshl_add_u32 v10, v3, 2, v10
  v_add_u32 v10, 4352, v10
  s_waitcnt lgkmcnt(0)
  s_barrier
  ds_read_b128 v[48:51], v126 offset:0
  s_waitcnt vmcnt(5)
  v_mov_b32_dpp v16, v64 row_ror:8 row_mask:0xf bank_mask:0xf
  v_mov_b32_dpp v17, v65 row_ror:8 row_mask:0xf bank_mask:0xf
  v_mov_b32_dpp v18, v68 row_ror:8 row_mask:0xf bank_mask:0xf
  v_mov_b32_dpp v19, v69 row_ror:8 row_mask:0xf bank_mask:0xf
  v_mov_b32_dpp v64, v66 row_ror:8 row_mask:0xf bank_mask:0xc
  v_mov_b32_dpp v65, v67 row_ror:8 row_mask:0xf bank_mask:0xc
  v_mov_b32_dpp v68, v70 row_ror:8 row_mask:0xf bank_mask:0xc
  v_mov_b32_dpp v69, v71 row_ror:8 row_mask:0xf bank_mask:0xc
  v_mov_b32_dpp v66, v16 quad_perm:[0,1,2,3] row_mask:0xf bank_mask:0x3
  v_mov_b32_dpp v67, v17 quad_perm:[0,1,2,3] row_mask:0xf bank_mask:0x3
  v_mov_b32_dpp v70, v18 quad_perm:[0,1,2,3] row_mask:0xf bank_mask:0x3
  v_mov_b32_dpp v71, v19 quad_perm:[0,1,2,3] row_mask:0xf bank_mask:0x3
  v_mov_b32_dpp v16, v72 row_ror:8 row_mask:0xf bank_mask:0xf
  v_mov_b32_dpp v17, v73 row_ror:8 row_mask:0xf bank_mask:0xf
  v_mov_b32_dpp v18, v76 row_ror:8 row_mask:0xf bank_mask:0xf
  v_mov_b32_dpp v19, v77 row_ror:8 row_mask:0xf bank_mask:0xf
  v_mov_b32_dpp v72, v74 row_ror:8 row_mask:0xf bank_mask:0xc
  v_mov_b32_dpp v73, v75 row_ror:8 row_mask:0xf bank_mask:0xc
  v_mov_b32_dpp v76, v78 row_ror:8 row_mask:0xf bank_mask:0xc
  v_mov_b32_dpp v77, v79 row_ror:8 row_mask:0xf bank_mask:0xc
  v_mov_b32_dpp v74, v16 quad_perm:[0,1,2,3] row_mask:0xf bank_mask:0x3
  v_mov_b32_dpp v75, v17 quad_perm:[0,1,2,3] row_mask:0xf bank_mask:0x3
  v_mov_b32_dpp v78, v18 quad_perm:[0,1,2,3] row_mask:0xf bank_mask:0x3
  v_mov_b32_dpp v79, v19 quad_perm:[0,1,2,3] row_mask:0xf bank_mask:0x3
  v_perm_b32 v80, v68, v64, s27
  v_perm_b32 v81, v76, v72, s27
  v_perm_b32 v82, v70, v66, s27
  v_perm_b32 v83, v78, v74, s27
  v_perm_b32 v84, v68, v64, s28
  v_perm_b32 v85, v76, v72, s28
  v_perm_b32 v86, v70, v66, s28
  v_perm_b32 v87, v78, v74, s28
  v_perm_b32 v88, v69, v65, s27
  v_perm_b32 v89, v77, v73, s27
  v_perm_b32 v90, v71, v67, s27
  v_perm_b32 v91, v79, v75, s27
  v_perm_b32 v92, v69, v65, s28
  v_perm_b32 v93, v77, v73, s28
  v_perm_b32 v94, v71, v67, s28
  v_perm_b32 v95, v79, v75, s28
  s_waitcnt lgkmcnt(0)
  v_mfma_f32_16x16x32_bf16 v[32:35], v[48:51], v[80:83], 0
  v_mfma_f32_16x16x32_bf16 v[36:39], v[48:51], v[84:87], 0
  v_mfma_f32_16x16x32_bf16 v[40:43], v[48:51], v[88:91], 0
  v_mfma_f32_16x16x32_bf16 v[44:47], v[48:51], v[92:95], 0
  s_mov_b64 exec, 0xffff
  s_nop 3
  ds_write_b128 v9, v[32:35] offset:0
  ds_write_b128 v9, v[36:39] offset:256
  ds_write_b128 v9, v[40:43] offset:512
  ds_write_b128 v9, v[44:47] offset:768
  s_mov_b64 exec, -1
  s_waitcnt lgkmcnt(0)
  s_barrier
  s_cmp_lg_u32 s3, 0
  s_cbranch_scc1 L_qw21
  ds_read2st64_b32 v[64:65], v10 offset0:0 offset1:1
  ds_read2st64_b32 v[66:67], v10 offset0:2 offset1:3
  ds_read2st64_b32 v[68:69], v10 offset0:8 offset1:9
  ds_read2st64_b32 v[70:71], v10 offset0:10 offset1:11
  ds_read2st64_b32 v[72:73], v10 offset0:16 offset1:17
  ds_read2st64_b32 v[74:75], v10 offset0:18 offset1:19
  ds_read2st64_b32 v[76:77], v10 offset0:24 offset1:25
  ds_read2st64_b32 v[78:79], v10 offset0:26 offset1:27
  ds_read2st64_b32 v[80:81], v10 offset0:32 offset1:33
  ds_read2st64_b32 v[82:83], v10 offset0:34 offset1:35
  ds_read2st64_b32 v[84:85], v10 offset0:40 offset1:41
  ds_read2st64_b32 v[86:87], v10 offset0:42 offset1:43
  ds_read2st64_b32 v[88:89], v10 offset0:48 offset1:49
  ds_read2st64_b32 v[90:91], v10 offset0:50 offset1:51
  ds_read2st64_b32 v[92:93], v10 offset0:56 offset1:57
  ds_read2st64_b32 v[94:95], v10 offset0:58 offset1:59
  s_waitcnt lgkmcnt(0)
  v_add_f32 v64, v64, v68
  v_add_f32 v65, v65, v69
  v_add_f32 v66, v66, v70
  v_add_f32 v67, v67, v71
  v_add_f32 v72, v72, v76
  v_add_f32 v73, v73, v77
  v_add_f32 v74, v74, v78
  v_add_f32 v75, v75, v79
  v_add_f32 v80, v80, v84
  v_add_f32 v81, v81, v85
  v_add_f32 v82, v82, v86
  v_add_f32 v83, v83, v87
  v_add_f32 v88, v88, v92
  v_add_f32 v89, v89, v93
  v_add_f32 v90, v90, v94
  v_add_f32 v91, v91, v95
  v_add_f32 v64, v64, v72
  v_add_f32 v65, v65, v73
  v_add_f32 v66, v66, v74
  v_add_f32 v67, v67, v75
  v_add_f32 v80, v80, v88
  v_add_f32 v81, v81, v89
  v_add_f32 v82, v82, v90
  v_add_f32 v83, v83, v91
  v_add_f32 v64, v64, v80
  v_add_f32 v65, v65, v81
  v_add_f32 v66, v66, v82
  v_add_f32 v67, v67, v83
  s_lshr_b32 s94, s20, 3
  s_lshl_b32 s94, s94, 13
  s_and_b32 s95, s20, 7
  s_lshl_b32 s95, s95, 8
  s_add_u32 s94, s94, s95
  s_waitcnt vmcnt(0)
  s_mov_b32 s31, 0
  s_branch L_pfc24
L_pf22:
  buffer_load_dword v125, v127, s[16:19], 0 offen sc1
  s_waitcnt vmcnt(0)
L_pfc24:
  v_cmp_gt_u32 vcc, 0x40000000, v125
  s_cbranch_vccz L_pfd23
  s_add_u32 s31, s31, 1
  s_cmp_ge_u32 s31, 131072
  s_cbranch_scc1 L_pfd23
  s_sleep 1
  s_branch L_pf22
L_pfd23:
  buffer_store_dwordx4 v[64:67], v5, s[12:15], s94 offen sc1
  buffer_load_dwordx4 v[128:131], v28, s[8:11], s96 offen nt
  s_add_u32 s96, s96, s78
  buffer_load_dwordx4 v[132:135], v28, s[8:11], s96 offen nt
  s_add_u32 s96, s96, s78
L_qw21:
  s_waitcnt vmcnt(3)
  buffer_load_dwordx4 v[136:139], v28, s[8:11], s23 offen nt
  s_add_u32 s23, s23, s78
  buffer_load_dwordx4 v[140:143], v28, s[8:11], s23 offen nt
  s_add_u32 s23, s23, s78
  buffer_load_dwordx4 v[144:147], v28, s[8:11], s23 offen nt
  s_add_u32 s23, s23, s78
  v_lshlrev_b32 v104, 16, v12
  v_and_b32 v105, 0xffff0000, v12
  v_lshlrev_b32 v106, 16, v13
  v_and_b32 v107, 0xffff0000, v13
  v_lshlrev_b32 v108, 16, v14
  v_and_b32 v109, 0xffff0000, v14
  v_lshlrev_b32 v110, 16, v15
  v_and_b32 v111, 0xffff0000, v15
  v_add_f32 v112, v104, v105
  v_add_f32 v112, v112, v106
  v_add_f32 v112, v112, v107
  v_add_f32 v112, v112, v108
  v_add_f32 v112, v112, v109
  v_add_f32 v112, v112, v110
  v_add_f32 v112, v112, v111
  s_nop 1
  v_add_f32_dpp v112, v112, v112 quad_perm:[1,0,3,2] row_mask:0xf bank_mask:0xf
  s_nop 1
  v_add_f32_dpp v112, v112, v112 quad_perm:[2,3,0,1] row_mask:0xf bank_mask:0xf
  s_nop 1
  v_add_f32_dpp v112, v112, v112 row_half_mirror row_mask:0xf bank_mask:0xf
  s_nop 1
  v_add_f32_dpp v112, v112, v112 row_mirror row_mask:0xf bank_mask:0xf
  v_mov_b32 v113, v112
  s_nop 1
  v_permlane16_swap_b32 v112, v113
  v_add_f32 v112, v112, v113
  v_mov_b32 v113, v112
  s_nop 1
  v_permlane32_swap_b32 v112, v113
  v_add_f32 v112, v112, v113
  v_mul_f32 v114, 0x3b000000, v112
  v_sub_f32 v113, v104, v114
  v_mul_f32 v115, v113, v113
  v_sub_f32 v113, v105, v114
  v_fmac_f32 v115, v113, v113
  v_sub_f32 v113, v106, v114
  v_fmac_f32 v115, v113, v113
  v_sub_f32 v113, v107, v114
  v_fmac_f32 v115, v113, v113
  v_sub_f32 v113, v108, v114
  v_fmac_f32 v115, v113, v113
  v_sub_f32 v113, v109, v114
  v_fmac_f32 v115, v113, v113
  v_sub_f32 v113, v110, v114
  v_fmac_f32 v115, v113, v113
  v_sub_f32 v113, v111, v114
  v_fmac_f32 v115, v113, v113
  s_nop 1
  v_add_f32_dpp v115, v115, v115 quad_perm:[1,0,3,2] row_mask:0xf bank_mask:0xf
  s_nop 1
  v_add_f32_dpp v115, v115, v115 quad_perm:[2,3,0,1] row_mask:0xf bank_mask:0xf
  s_nop 1
  v_add_f32_dpp v115, v115, v115 row_half_mirror row_mask:0xf bank_mask:0xf
  s_nop 1
  v_add_f32_dpp v115, v115, v115 row_mirror row_mask:0xf bank_mask:0xf
  v_mov_b32 v113, v115
  s_nop 1
  v_permlane16_swap_b32 v115, v113
  v_add_f32 v115, v115, v113
  v_mov_b32 v113, v115
  s_nop 1
  v_permlane32_swap_b32 v115, v113
  v_add_f32 v115, v115, v113
  v_mul_f32 v115, 0x3b000000, v115
  v_cvt_pk_bf16_f32 v113, v114, v115
  v_lshlrev_b32 v114, 16, v113
  v_and_b32 v115, 0xffff0000, v113
  v_add_f32 v115, 0x3727c5ac, v115
  v_cvt_pk_bf16_f32 v113, v115, v115
  v_and_b32 v115, 0xffff0000, v113
  v_sqrt_f32 v115, v115
  s_nop 0
  v_cvt_pk_bf16_f32 v113, v115, v115
  v_and_b32 v115, 0xffff0000, v113
  v_rcp_f32 v115, v115
  s_lshl_b32 s24, s25, 3
  v_mov_b32 v124, s24
  s_mov_b64 exec, 1
  ds_write_b64 v124, v[114:115] offset:20736
  s_mov_b64 exec, -1
  s_waitcnt vmcnt(4)
  buffer_load_dwordx4 v[148:151], v28, s[8:11], s23 offen nt
  s_add_u32 s23, s23, s78
  s_waitcnt vmcnt(4)
  buffer_load_dwordx4 v[152:155], v28, s[8:11], s23 offen nt
  s_add_u32 s23, s23, s78
  s_waitcnt vmcnt(4)
  buffer_load_dwordx4 v[156:159], v28, s[8:11], s23 offen nt
  s_add_u32 s23, s23, 204800
  s_waitcnt vmcnt(4)
  buffer_load_dwordx4 v[160:163], v28, s[8:11], s23 offen nt
  s_add_u32 s23, s23, s78
  s_waitcnt vmcnt(4)
  buffer_load_dwordx4 v[164:167], v28, s[8:11], s23 offen nt
  s_add_u32 s23, s23, s78
  s_waitcnt vmcnt(4)
  buffer_load_dwordx4 v[168:171], v28, s[8:11], s23 offen nt
  s_add_u32 s23, s23, s78
  s_waitcnt vmcnt(4)
  buffer_load_dwordx4 v[172:175], v28, s[8:11], s23 offen nt
  s_add_u32 s23, s23, s78
  s_waitcnt vmcnt(4)
  buffer_load_dwordx4 v[176:179], v28, s[8:11], s23 offen nt
  s_add_u32 s23, s23, s78
  s_waitcnt vmcnt(4)
  buffer_load_dwordx4 v[180:183], v28, s[8:11], s23 offen nt
  s_add_u32 s23, s23, s78
  s_waitcnt vmcnt(4)
  buffer_load_dwordx4 v[184:187], v28, s[8:11], s23 offen nt
  s_add_u32 s23, s23, s78
  s_waitcnt vmcnt(4)
  buffer_load_dwordx4 v[188:191], v28, s[8:11], s23 offen nt
  v_lshlrev_b32 v124, 3, v3
  v_add_u32 v114, s29, v11
  v_lshl_add_u32 v115, v3, 5, v114
  v_and_b32 v112, 3, v1
  v_lshlrev_b32 v112, 9, v112
  v_lshrrev_b32 v113, 2, v1
  v_lshl_add_u32 v112, v113, 4, v112
  s_lshl_b32 s24, s25, 2
  s_add_u32 s24, s24, 4352
  v_add_u32 v112, s24, v112
  v_lshlrev_b32 v113, 2, v1
  s_lshl_b32 s95, s25, 13
  s_lshl_b32 s94, s20, 8
  s_add_u32 s95, s95, s94
  s_add_u32 s95, s95, 65536
  v_lshlrev_b32 v114, 1, v114
  s_movk_i32 s92, 0x2000
  s_movk_i32 s93, 0x4000
  s_movk_i32 s94, 0x6000
  s_waitcnt lgkmcnt(0)
  s_barrier
  ds_read_b64 v[100:101], v124 offset:20736
  v_lshlrev_b32 v104, 16, v98
  v_and_b32 v105, 0xffff0000, v98
  v_lshlrev_b32 v106, 16, v99
  v_and_b32 v107, 0xffff0000, v99
  buffer_load_dwordx4 v[116:119], v114, s[12:15], 0 offen sc1
  buffer_load_dwordx4 v[120:123], v114, s[12:15], s92 offen sc1
  buffer_load_dwordx4 v[16:19], v114, s[12:15], s93 offen sc1
  buffer_load_dwordx4 v[20:23], v114, s[12:15], s94 offen sc1
  s_waitcnt lgkmcnt(0)
  v_sub_f32 v104, v104, v100
  v_sub_f32 v105, v105, v100
  v_sub_f32 v106, v106, v100
  v_sub_f32 v107, v107, v100
  v_cvt_pk_bf16_f32 v98, v104, v105
  v_lshlrev_b32 v104, 16, v98
  v_and_b32 v105, 0xffff0000, v98
  v_cvt_pk_bf16_f32 v99, v106, v107
  v_lshlrev_b32 v106, 16, v99
  v_and_b32 v107, 0xffff0000, v99
  v_mul_f32 v104, v104, v101
  v_mul_f32 v105, v105, v101
  v_mul_f32 v106, v106, v101
  v_mul_f32 v107, v107, v101
  v_cvt_pk_bf16_f32 v98, v104, v105
  v_lshlrev_b32 v104, 16, v98
  v_and_b32 v105, 0xffff0000, v98
  v_cvt_pk_bf16_f32 v99, v106, v107
  v_lshlrev_b32 v106, 16, v99
  v_and_b32 v107, 0xffff0000, v99
  s_waitcnt vmcnt(12)
  v_perm_b32 v64, v132, v128, s27
  v_perm_b32 v65, v140, v136, s27
  v_perm_b32 v66, v148, v144, s27
  v_perm_b32 v67, v156, v152, s27
  v_perm_b32 v68, v132, v128, s28
  v_perm_b32 v69, v140, v136, s28
  v_perm_b32 v70, v148, v144, s28
  v_perm_b32 v71, v156, v152, s28
  v_perm_b32 v72, v133, v129, s27
  v_perm_b32 v73, v141, v137, s27
  v_perm_b32 v74, v149, v145, s27
  v_perm_b32 v75, v157, v153, s27
  v_perm_b32 v76, v133, v129, s28
  v_perm_b32 v77, v141, v137, s28
  v_perm_b32 v78, v149, v145, s28
  v_perm_b32 v79, v157, v153, s28
  v_perm_b32 v80, v134, v130, s27
  v_perm_b32 v81, v142, v138, s27
  v_perm_b32 v82, v150, v146, s27
  v_perm_b32 v83, v158, v154, s27
  v_perm_b32 v84, v134, v130, s28
  v_perm_b32 v85, v142, v138, s28
  v_perm_b32 v86, v150, v146, s28
  v_perm_b32 v87, v158, v154, s28
  v_perm_b32 v88, v135, v131, s27
  v_perm_b32 v89, v143, v139, s27
  v_perm_b32 v90, v151, v147, s27
  v_perm_b32 v91, v159, v155, s27
  v_perm_b32 v92, v135, v131, s28
  v_perm_b32 v93, v143, v139, s28
  v_perm_b32 v94, v151, v147, s28
  v_perm_b32 v95, v159, v155, s28
  s_waitcnt vmcnt(4)
  v_perm_b32 v192, v164, v160, s27
  v_perm_b32 v193, v172, v168, s27
  v_perm_b32 v194, v180, v176, s27
  v_perm_b32 v195, v188, v184, s27
  v_perm_b32 v196, v164, v160, s28
  v_perm_b32 v197, v172, v168, s28
  v_perm_b32 v198, v180, v176, s28
  v_perm_b32 v199, v188, v184, s28
  v_perm_b32 v200, v165, v161, s27
  v_perm_b32 v201, v173, v169, s27
  v_perm_b32 v202, v181, v177, s27
  v_perm_b32 v203, v189, v185, s27
  v_perm_b32 v204, v165, v161, s28
  v_perm_b32 v205, v173, v169, s28
  v_perm_b32 v206, v181, v177, s28
  v_perm_b32 v207, v189, v185, s28
  v_perm_b32 v208, v166, v162, s27
  v_perm_b32 v209, v174, v170, s27
  v_perm_b32 v210, v182, v178, s27
  v_perm_b32 v211, v190, v186, s27
  v_perm_b32 v212, v166, v162, s28
  v_perm_b32 v213, v174, v170, s28
  v_perm_b32 v214, v182, v178, s28
  v_perm_b32 v215, v190, v186, s28
  v_perm_b32 v216, v167, v163, s27
  v_perm_b32 v217, v175, v171, s27
  v_perm_b32 v218, v183, v179, s27
  v_perm_b32 v219, v191, v187, s27
  v_perm_b32 v220, v167, v163, s28
  v_perm_b32 v221, v175, v171, s28
  v_perm_b32 v222, v183, v179, s28
  v_perm_b32 v223, v191, v187, s28
  s_waitcnt vmcnt(0)
  v_max3_u32 v96, v116, v117, v118
  v_max3_u32 v96, v96, v119, v120
  v_max3_u32 v96, v96, v121, v122
  v_max3_u32 v96, v96, v123, v16
  v_max3_u32 v96, v96, v17, v18
  v_max3_u32 v96, v96, v19, v20
  v_max3_u32 v96, v96, v21, v22
  v_max_u32 v96, v96, v23
  v_cmp_eq_u32 vcc, -1, v96
  s_cbranch_vccz L_sok25
  s_mov_b32 s31, 0
L_pd26:
  buffer_load_dwordx4 v[116:119], v114, s[12:15], 0 offen sc1
  buffer_load_dwordx4 v[120:123], v114, s[12:15], s92 offen sc1
  buffer_load_dwordx4 v[16:19], v114, s[12:15], s93 offen sc1
  buffer_load_dwordx4 v[20:23], v114, s[12:15], s94 offen sc1
  s_waitcnt vmcnt(0)
  v_max3_u32 v96, v116, v117, v118
  v_max3_u32 v96, v96, v119, v120
  v_max3_u32 v96, v96, v121, v122
  v_max3_u32 v96, v96, v123, v16
  v_max3_u32 v96, v96, v17, v18
  v_max3_u32 v96, v96, v19, v20
  v_max3_u32 v96, v96, v21, v22
  v_max_u32 v96, v96, v23
  v_cmp_eq_u32 vcc, -1, v96
  s_cbranch_vccz L_pdd27
  s_add_u32 s31, s31, 1
  s_cmp_ge_u32 s31, 131072
  s_cbranch_scc1 L_pdd27
  s_sleep 1
  s_branch L_pd26
L_pdd27:
L_sok25:
  v_add_f32 v116, v116, v16
  v_add_f32 v117, v117, v17
  v_add_f32 v118, v118, v18
  v_add_f32 v119, v119, v19
  v_add_f32 v120, v120, v20
  v_add_f32 v121, v121, v21
  v_add_f32 v122, v122, v22
  v_add_f32 v123, v123, v23
  v_cvt_pk_bf16_f32 v96, v116, v117
  v_lshlrev_b32 v116, 16, v96
  v_and_b32 v117, 0xffff0000, v96
  v_cvt_pk_bf16_f32 v97, v118, v119
  v_lshlrev_b32 v118, 16, v97
  v_and_b32 v119, 0xffff0000, v97
  v_cvt_pk_bf16_f32 v98, v120, v121
  v_lshlrev_b32 v120, 16, v98
  v_and_b32 v121, 0xffff0000, v98
  v_cvt_pk_bf16_f32 v99, v122, v123
  v_lshlrev_b32 v122, 16, v99
  v_and_b32 v123, 0xffff0000, v99
  v_add_f32 v120, 1.0, v120
  v_add_f32 v121, 1.0, v121
  v_add_f32 v122, 1.0, v122
  v_add_f32 v123, 1.0, v123
  v_cvt_pk_bf16_f32 v96, v120, v121
  v_lshlrev_b32 v120, 16, v96
  v_and_b32 v121, 0xffff0000, v96
  v_cvt_pk_bf16_f32 v97, v122, v123
  v_lshlrev_b32 v122, 16, v97
  v_and_b32 v123, 0xffff0000, v97
  v_mul_f32 v104, v104, v120
  v_mul_f32 v105, v105, v121
  v_mul_f32 v106, v106, v122
  v_mul_f32 v107, v107, v123
  v_cvt_pk_bf16_f32 v96, v104, v105
  v_lshlrev_b32 v104, 16, v96
  v_and_b32 v105, 0xffff0000, v96
  v_cvt_pk_bf16_f32 v97, v106, v107
  v_lshlrev_b32 v106, 16, v97
  v_and_b32 v107, 0xffff0000, v97
  v_add_f32 v104, v104, v116
  v_add_f32 v105, v105, v117
  v_add_f32 v106, v106, v118
  v_add_f32 v107, v107, v119
  v_cvt_pk_bf16_f32 v96, v104, v105
  v_cvt_pk_bf16_f32 v97, v106, v107
  ds_write_b64 v115, v[96:97] offset:0
  s_waitcnt lgkmcnt(0)
  ds_read_b128 v[116:119], v8 offset:0
  ds_read_b128 v[120:123], v8 offset:64
  s_waitcnt lgkmcnt(1)
  v_mfma_f32_16x16x32_bf16 v[32:35], v[116:119], v[64:67], 0
  v_mfma_f32_16x16x32_bf16 v[36:39], v[116:119], v[68:71], 0
  v_mfma_f32_16x16x32_bf16 v[40:43], v[116:119], v[72:75], 0
  v_mfma_f32_16x16x32_bf16 v[44:47], v[116:119], v[76:79], 0
  v_mfma_f32_16x16x32_bf16 v[48:51], v[116:119], v[80:83], 0
  v_mfma_f32_16x16x32_bf16 v[52:55], v[116:119], v[84:87], 0
  v_mfma_f32_16x16x32_bf16 v[56:59], v[116:119], v[88:91], 0
  v_mfma_f32_16x16x32_bf16 v[60:63], v[116:119], v[92:95], 0
  s_waitcnt lgkmcnt(0)
  v_mfma_f32_16x16x32_bf16 v[32:35], v[120:123], v[192:195], v[32:35]
  v_mfma_f32_16x16x32_bf16 v[36:39], v[120:123], v[196:199], v[36:39]
  v_mfma_f32_16x16x32_bf16 v[40:43], v[120:123], v[200:203], v[40:43]
  v_mfma_f32_16x16x32_bf16 v[44:47], v[120:123], v[204:207], v[44:47]
  v_mfma_f32_16x16x32_bf16 v[48:51], v[120:123], v[208:211], v[48:51]
  v_mfma_f32_16x16x32_bf16 v[52:55], v[120:123], v[212:215], v[52:55]
  v_mfma_f32_16x16x32_bf16 v[56:59], v[120:123], v[216:219], v[56:59]
  v_mfma_f32_16x16x32_bf16 v[60:63], v[120:123], v[220:223], v[60:63]
  s_mov_b64 exec, 0xffff
  ds_write_b128 v9, v[32:35] offset:0
  ds_write_b128 v9, v[36:39] offset:256
  ds_write_b128 v9, v[40:43] offset:512
  ds_write_b128 v9, v[44:47] offset:768
  ds_write_b128 v9, v[48:51] offset:1024
  ds_write_b128 v9, v[52:55] offset:1280
  ds_write_b128 v9, v[56:59] offset:1536
  ds_write_b128 v9, v[60:63] offset:1792
  s_mov_b64 exec, -1
  v_mov_b32 v96, 0
  ds_write_b32 v96, v96 offset:26616
  s_waitcnt lgkmcnt(0)
  s_barrier
  s_cmp_ge_u32 s3, 4
  s_cbranch_scc1 L_noq28
  ds_read2st64_b32 v[32:33], v112 offset0:0 offset1:1
  ds_read2st64_b32 v[34:35], v112 offset0:8 offset1:9
  ds_read2st64_b32 v[36:37], v112 offset0:16 offset1:17
  ds_read2st64_b32 v[38:39], v112 offset0:24 offset1:25
  ds_read2st64_b32 v[40:41], v112 offset0:32 offset1:33
  ds_read2st64_b32 v[42:43], v112 offset0:40 offset1:41
  ds_read2st64_b32 v[44:45], v112 offset0:48 offset1:49
  ds_read2st64_b32 v[46:47], v112 offset0:56 offset1:57
  s_waitcnt lgkmcnt(0)
  v_add_f32 v32, v32, v34
  v_add_f32 v33, v33, v35
  v_add_f32 v36, v36, v38
  v_add_f32 v37, v37, v39
  v_add_f32 v40, v40, v42
  v_add_f32 v41, v41, v43
  v_add_f32 v44, v44, v46
  v_add_f32 v45, v45, v47
  v_add_f32 v32, v32, v36
  v_add_f32 v33, v33, v37
  v_add_f32 v40, v40, v44
  v_add_f32 v41, v41, v45
  v_add_f32 v32, v32, v40
  v_add_f32 v33, v33, v41
  v_cvt_pk_bf16_f32 v32, v32, v33
  buffer_store_dword v32, v113, s[12:15], s95 offen sc1
L_noq28:
  s_barrier
  s_mov_b32 s21, 6
  s_lshr_b32 s25, s20, 3
  s_and_b32 s26, s20, 7
  s_lshl_b32 s24, s20, 21
  v_lshlrev_b32 v3, 4, v1
  v_and_b32 v2, 12, v1
  v_lshlrev_b32 v2, 6, v2
  v_and_b32 v4, 48, v1
  v_lshl_add_u32 v2, v4, 2, v2
  v_and_b32 v4, 3, v1
  v_lshl_add_u32 v2, v4, 4, v2
  s_add_u32 s4, s38, s24
  s_addc_u32 s5, s39, 0
  s_mov_b32 s6, 0x200000
  s_mov_b32 s7, 0x20000
  s_add_u32 s8, s40, s24
  s_addc_u32 s9, s41, 0
  s_mov_b32 s10, 0x200000
  s_mov_b32 s11, 0x20000
  s_mov_b32 s29, 0x3db504f3
  v_lshlrev_b32 v6, 8, v4
  v_lshrrev_b32 v7, 2, v1
  v_lshl_add_u32 v6, v7, 4, v6
  v_lshrrev_b32 v5, 5, v1
  v_mul_u32_u24 v5, 136, v5
  s_lshl_b32 s65, s25, 13
  s_lshl_b32 s66, s26, 10
  s_add_u32 s65, s65, s66
  s_add_u32 s65, s65, 65536
  s_mul_i32 s64, s20, 40960
  s_add_u32 s64, s64, 171520
  s_cmp_eq_u32 s21, 7
  s_cselect_b32 s91, 1769472, -1
  s_mov_b32 s22, s3
  s_mul_i32 s22, s22, 4096
  s_add_u32 s22, s22, 1376256
  buffer_load_dword v252, v5, s[16:19], 0 offen sc1
  buffer_load_dwordx4 v[232:235], v6, s[12:15], s65 offen sc1
  s_waitcnt vmcnt(6)
  buffer_load_dwordx4 v[200:203], v2, s[4:7], s22 offen offset:0 nt
  s_waitcnt vmcnt(6)
  buffer_load_dwordx4 v[204:207], v2, s[4:7], s22 offen offset:1024 nt
  s_waitcnt vmcnt(6)
  buffer_load_dwordx4 v[208:211], v2, s[4:7], s22 offen offset:2048 nt
  s_waitcnt vmcnt(6)
  buffer_load_dwordx4 v[212:215], v2, s[4:7], s22 offen offset:3072 nt
  v_mov_b32 v8, 0
  v_mov_b32 v9, 0
  v_mov_b32 v10, 0
  v_mov_b32 v11, 0
  v_mov_b32 v12, 0
  v_mov_b32 v13, 0
  v_mov_b32 v14, 0
  v_mov_b32 v15, 0
  v_mov_b32 v16, 0
  v_mov_b32 v17, 0
  v_mov_b32 v18, 0
  v_mov_b32 v19, 0
  v_mov_b32 v20, 0
  v_mov_b32 v21, 0
  v_mov_b32 v22, 0
  v_mov_b32 v23, 0
  v_mov_b32 v24, 0
  v_mov_b32 v25, 0
  v_mov_b32 v26, 0
  v_mov_b32 v27, 0
  v_mov_b32 v28, 0
  v_mov_b32 v29, 0
  v_mov_b32 v30, 0
  v_mov_b32 v31, 0
  s_mov_b32 s32, 0x000f000f
  s_mov_b32 s33, 0x000f000f
  v_mov_b32 v18, 0
  v_mov_b32 v22, 0
  v_mov_b32 v26, 0
  v_mov_b32 v30, 0
  v_mov_b32 v42, 0
  v_mov_b32 v46, 0
  v_mov_b32 v50, 0
  v_mov_b32 v54, 0
  v_mov_b32 v58, 0
  v_mov_b32 v62, 0
  v_mov_b32 v66, 0
  v_mov_b32 v70, 0
  v_mov_b32 v19, 0
  v_mov_b32 v23, 0
  v_mov_b32 v27, 0
  v_mov_b32 v31, 0
  v_mov_b32 v43, 0
  v_mov_b32 v47, 0
  v_mov_b32 v51, 0
  v_mov_b32 v55, 0
  v_mov_b32 v59, 0
  v_mov_b32 v63, 0
  v_mov_b32 v67, 0
  v_mov_b32 v71, 0
  s_mul_i32 s24, s3, 2112
  v_mul_u32_u24 v93, 528, v4
  v_and_b32 v94, 48, v1
  v_add3_u32 v93, v93, v94, s24
  v_and_b32 v94, 12, v1
  v_lshl_add_u32 v93, v94, 4, v93
  s_lshl_b32 s24, s3, 5
  s_add_u32 s24, s24, 16896
  v_lshl_add_u32 v96, v4, 3, s24
  s_lshr_b32 s66, s3, 1
  s_lshl_b32 s24, s66, 3
  s_add_u32 s24, s24, 16896
  v_and_b32 v97, 7, v1
  v_lshl_add_u32 v97, v97, 5, s24
  s_lshl_b32 s67, s26, 2
  s_add_u32 s67, s67, s66
  s_mul_i32 s67, s67, 40960
  s_add_u32 s67, s67, 131072
  s_mul_i32 s24, s66, 528
  s_and_b32 s76, s3, 1
  s_lshl_b32 s76, s76, 8
  s_add_u32 s24, s24, s76
  v_lshl_add_u32 v94, v1, 2, s24
  v_lshlrev_b32 v95, 2, v1
  s_lshl_b32 s24, s25, 3
  s_add_u32 s24, s24, s21
  s_lshl_b32 s24, s24, 9
  s_add_u32 s24, s24, s76
  s_add_u32 s80, s24, s67
  s_lshr_b32 s24, s24, 1
  s_add_u32 s79, s24, s67
  s_add_u32 s79, s79, 16384
  v_mov_b32 v100, 0
  v_mov_b32 v101, 1
  v_mov_b32 v88, 0xff7fffff
  v_mov_b32 v89, 0
  s_waitcnt vmcnt(4)
  s_mov_b32 s31, 0
  s_branch L_pfc31
L_pf29:
  buffer_load_dword v252, v5, s[16:19], 0 offen sc1
  s_waitcnt vmcnt(0)
L_pfc31:
  v_cmp_gt_u32 vcc, 0x40000000, v252
  s_cbranch_vccz L_pfd30
  s_add_u32 s31, s31, 1
  s_cmp_ge_u32 s31, 131072
  s_cbranch_scc1 L_pfd30
  s_sleep 4
  s_branch L_pf29
L_pfd30:
  v_max3_u32 v252, v232, v233, v234
  v_max_u32 v252, v252, v235
  v_cmp_eq_u32 vcc, -1, v252
  s_cbranch_vccz L_qok32
  s_mov_b32 s31, 0
L_pd33:
  buffer_load_dwordx4 v[232:235], v6, s[12:15], s65 offen sc1
  s_waitcnt vmcnt(0)
  v_max3_u32 v252, v232, v233, v234
  v_max_u32 v252, v252, v235
  v_cmp_eq_u32 vcc, -1, v252
  s_cbranch_vccz L_pdd34
  s_add_u32 s31, s31, 1
  s_cmp_ge_u32 s31, 131072
  s_cbranch_scc1 L_pdd34
  s_sleep 2
  s_branch L_pd33
L_pdd34:
L_qok32:
  v_mov_b32 v253, 1
  s_mov_b64 exec, 1
  buffer_atomic_add v253, off, s[12:15], s64 sc0 sc1
  s_mov_b64 exec, -1
  s_waitcnt vmcnt(6)
  buffer_load_dwordx4 v[216:219], v3, s[8:11], s22 offen offset:0 nt
  s_waitcnt vmcnt(6)
  buffer_load_dwordx4 v[220:223], v3, s[8:11], s22 offen offset:1024 nt
  s_waitcnt vmcnt(6)
  buffer_load_dwordx4 v[224:227], v3, s[8:11], s22 offen offset:2048 nt
  s_waitcnt vmcnt(6)
  buffer_load_dwordx4 v[228:231], v3, s[8:11], s22 offen offset:3072 nt
  s_branch L_att_loop
L_erole:
  s_sub_u32 s20, 31, s2
  v_and_b32 v2, 15, v1
  v_lshrrev_b32 v3, 4, v1
  s_lshl_b32 s29, s3, 7
  v_lshlrev_b32 v7, 10, v3
  v_lshl_add_u32 v11, v2, 3, v7
  s_add_u32 s98, s20, 16
  v_lshrrev_b32 v10, 3, v2
  v_lshl_add_u32 v10, v10, 2, v3
  v_and_b32 v5, 7, v2
  v_lshlrev_b32 v5, 4, v5
  v_mul_u32_u24 v6, 49152, v10
  v_add_u32 v6, v6, v5
  v_and_b32 v10, 8, v2
  v_add3_u32 v5, v10, v5, v7
  v_lshlrev_b32 v30, 3, v0
  s_mul_i32 s92, s3, 393216
  s_lshl_b32 s24, s98, 7
  s_add_u32 s92, s92, s24
  s_movk_i32 s97, 6144
  s_mul_i32 s21, s20, 40960
  s_add_u32 s21, s21, 131072
  v_mov_b32 v132, -1
  v_mov_b32 v133, -1
  v_mov_b32 v134, -1
  v_mov_b32 v135, -1
  v_lshlrev_b32 v28, 4, v0
  s_waitcnt lgkmcnt(0)
  s_mov_b32 s12, s62
  s_mov_b32 s13, s63
  s_mov_b32 s14, 0x400000
  s_mov_b32 s15, 0x20000
  s_mov_b32 s16, s60
  s_mov_b32 s17, s61
  s_mov_b32 s18, 0x100
  s_mov_b32 s19, 0x20000
  s_cmp_ge_u32 s2, 3
  s_cbranch_scc1 L_nr35
  s_lshl_b32 s96, s2, 15
  buffer_store_dwordx4 v[132:135], v28, s[12:15], s96 offen sc1
  s_add_u32 s96, s96, 8192
  buffer_store_dwordx4 v[132:135], v28, s[12:15], s96 offen sc1
  s_add_u32 s96, s96, 8192
  buffer_store_dwordx4 v[132:135], v28, s[12:15], s96 offen sc1
  s_add_u32 s96, s96, 8192
  buffer_store_dwordx4 v[132:135], v28, s[12:15], s96 offen sc1
  s_add_u32 s96, s96, 8192
  v_mov_b32 v29, 0x40000000
  s_lshl_b32 s96, s2, 2
  s_waitcnt vmcnt(0)
  s_barrier
  s_cmp_lg_u32 s3, 0
  s_cbranch_scc1 L_nr35
  s_mov_b64 exec, 1
  buffer_store_dword v29, off, s[16:19], s96 offset:128 sc1
  s_mov_b64 exec, -1
L_nr35:
  s_mov_b32 s4, s56
  s_mov_b32 s5, s57
  s_mov_b32 s6, 0x300000
  s_mov_b32 s7, 0x20000
  s_mov_b32 s68, s54
  s_mov_b32 s69, s55
  s_mov_b32 s70, 0x1000
  s_mov_b32 s71, 0x20000
  buffer_load_dwordx2 v[104:105], v30, s[68:71], 0 offen
  buffer_load_dwordx4 v[64:67], v6, s[4:7], s92 offen nt
  s_add_u32 s92, s92, s97
  buffer_load_dwordx4 v[68:71], v6, s[4:7], s92 offen nt
  s_add_u32 s92, s92, s97
  buffer_load_dwordx4 v[72:75], v6, s[4:7], s92 offen nt
  s_add_u32 s92, s92, s97
  buffer_load_dwordx4 v[76:79], v6, s[4:7], s92 offen nt
  s_add_u32 s92, s92, s97
  buffer_load_dwordx4 v[80:83], v6, s[4:7], s92 offen nt
  s_add_u32 s92, s92, s97
  buffer_load_dwordx4 v[84:87], v6, s[4:7], s92 offen nt
  s_add_u32 s92, s92, s97
  buffer_load_dwordx4 v[88:91], v6, s[4:7], s92 offen nt
  s_add_u32 s92, s92, s97
  buffer_load_dwordx4 v[92:95], v6, s[4:7], s92 offen nt
  s_mov_b32 s88, s58
  s_mov_b32 s89, s59
  s_mov_b32 s90, 0x1000
  s_mov_b32 s91, 0x20000
  s_mov_b32 s64, s36
  s_mov_b32 s65, s37
  s_mov_b32 s66, 0x1000
  s_mov_b32 s67, 0x20000
  s_getreg_b32 s10, hwreg(HW_REG_XCC_ID, 0, 4)
  s_mul_i32 s24, s10, s10
  s_lshl_b32 s24, s24, 12
  s_add_u32 s10, s10, s24
  s_add_u32 s10, s10, 0x2000000
  s_mov_b32 s27, 0x05040100
  s_mov_b32 s28, 0x07060302
  s_mov_b32 s30, 0x3fb8aa3b
  v_and_b32 v8, 3, v1
  v_mul_u32_u24 v8, 1056, v8
  v_lshl_add_u32 v8, v3, 4, v8
  v_add_u32 v8, s29, v8
  s_lshl_b32 s24, s3, 11
  s_add_u32 s24, s24, 4352
  v_lshl_add_u32 v9, v2, 4, s24
  s_mov_b32 s93, 0x32a5705f
  s_waitcnt vmcnt(8)
  v_lshlrev_b32 v112, 16, v104
  v_and_b32 v113, 0xffff0000, v104
  v_lshlrev_b32 v114, 16, v105
  v_and_b32 v115, 0xffff0000, v105
  v_mul_f32 v116, s30, v112
  v_mul_f32 v117, s30, v113
  v_mul_f32 v118, s30, v114
  v_mul_f32 v119, s30, v115
  v_fma_f32 v120, v112, s30, -v116
  v_fma_f32 v121, v113, s30, -v117
  v_fma_f32 v122, v114, s30, -v118
  v_fma_f32 v123, v115, s30, -v119
  v_fma_f32 v120, v112, s93, v120
  v_fma_f32 v121, v113, s93, v121
  v_fma_f32 v122, v114, s93, v122
  v_fma_f32 v123, v115, s93, v123
  v_rndne_f32 v124, v116
  v_rndne_f32 v125, v117
  v_rndne_f32 v126, v118
  v_rndne_f32 v127, v119
  v_sub_f32 v116, v116, v124
  v_sub_f32 v117, v117, v125
  v_sub_f32 v118, v118, v126
  v_sub_f32 v119, v119, v127
  v_add_f32 v116, v116, v120
  v_add_f32 v117, v117, v121
  v_add_f32 v118, v118, v122
  v_add_f32 v119, v119, v123
  v_exp_f32 v116, -v116
  v_exp_f32 v117, -v117
  v_exp_f32 v118, -v118
  v_exp_f32 v119, -v119
  v_cvt_i32_f32 v124, -v124
  v_cvt_i32_f32 v125, -v125
  v_cvt_i32_f32 v126, -v126
  v_cvt_i32_f32 v127, -v127
  v_ldexp_f32 v116, v116, v124
  v_ldexp_f32 v117, v117, v125
  v_ldexp_f32 v118, v118, v126
  v_ldexp_f32 v119, v119, v127
  v_add_f32 v116, 1.0, v116
  v_add_f32 v117, 1.0, v117
  v_add_f32 v118, 1.0, v118
  v_add_f32 v119, 1.0, v119
  v_rcp_f32 v120, v116
  v_rcp_f32 v121, v117
  v_rcp_f32 v122, v118
  v_rcp_f32 v123, v119
  v_fma_f32 v124, -v116, v120, 1.0
  v_fma_f32 v125, -v117, v121, 1.0
  v_fma_f32 v126, -v118, v122, 1.0
  v_fma_f32 v127, -v119, v123, 1.0
  v_fma_f32 v120, v124, v120, v120
  v_fma_f32 v121, v125, v121, v121
  v_fma_f32 v122, v126, v122, v122
  v_fma_f32 v123, v127, v123, v123
  v_mul_f32 v124, v112, v120
  v_mul_f32 v125, v113, v121
  v_mul_f32 v126, v114, v122
  v_mul_f32 v127, v115, v123
  v_fma_f32 v128, -v116, v124, v112
  v_fma_f32 v129, -v117, v125, v113
  v_fma_f32 v130, -v118, v126, v114
  v_fma_f32 v131, -v119, v127, v115
  v_fma_f32 v124, v128, v120, v124
  v_fma_f32 v125, v129, v121, v125
  v_fma_f32 v126, v130, v122, v126
  v_fma_f32 v127, v131, v123, v127
  v_div_fixup_f32 v112, v124, v116, v112
  v_div_fixup_f32 v113, v125, v117, v113
  v_div_fixup_f32 v114, v126, v118, v114
  v_div_fixup_f32 v115, v127, v119, v115
  v_cvt_pk_bf16_f32 v104, v112, v113
  v_cvt_pk_bf16_f32 v105, v114, v115
  v_lshrrev_b32 v29, 7, v0
  v_lshl_add_u32 v29, v29, 5, v30
  ds_write_b64 v29, v[104:105] offset:0
  s_add_u32 s24, s21, 0
  buffer_store_dwordx4 v[132:135], v28, s[12:15], s24 offen sc1
  s_add_u32 s24, s21, 8192
  buffer_store_dwordx4 v[132:135], v28, s[12:15], s24 offen sc1
  s_add_u32 s24, s21, 16384
  buffer_store_dwordx4 v[132:135], v28, s[12:15], s24 offen sc1
  s_add_u32 s24, s21, 24576
  buffer_store_dwordx4 v[132:135], v28, s[12:15], s24 offen sc1
  s_add_u32 s24, s21, 32768
  buffer_store_dwordx4 v[132:135], v28, s[12:15], s24 offen sc1
  buffer_load_dword v30, off, s[16:19], 0 offset:132 sc1
  s_mov_b32 s72, s44
  s_mov_b32 s73, s45
  s_mov_b32 s74, 0x400000
  s_mov_b32 s75, 0x20000
  s_movk_i32 s96, 0x2000
  v_and_b32 v11, 7, v2
  v_lshlrev_b32 v11, 4, v11
  v_and_b32 v28, 1, v3
  v_lshlrev_b32 v28, 16, v28
  v_lshrrev_b32 v6, 1, v3
  v_lshl_add_u32 v28, v6, 10, v28
  v_and_b32 v6, 8, v2
  v_lshl_add_u32 v28, v6, 8, v28
  v_add_u32 v28, v28, v11
  s_lshl_b32 s23, s20, 17
  s_add_u32 s23, s23, s29
  buffer_load_dwordx4 v[192:195], v28, s[72:75], s23 offen nt
  s_add_u32 s23, s23, s96
  buffer_load_dwordx4 v[196:199], v28, s[72:75], s23 offen nt
  s_add_u32 s23, s23, s96
  s_waitcnt lgkmcnt(0)
  s_barrier
  ds_read_b128 v[48:51], v8 offset:0
  ds_read_b128 v[52:55], v8 offset:64
  v_lshlrev_b32 v10, 4, v2
  v_lshl_add_u32 v10, v3, 2, v10
  v_add_u32 v10, 4352, v10
  s_waitcnt lgkmcnt(0)
  s_waitcnt vmcnt(8)
  buffer_load_dwordx4 v[200:203], v28, s[72:75], s23 offen nt
  s_add_u32 s23, s23, s96
  buffer_load_dwordx4 v[204:207], v28, s[72:75], s23 offen nt
  s_add_u32 s23, s23, s96
  buffer_load_dwordx4 v[208:211], v28, s[72:75], s23 offen nt
  s_add_u32 s23, s23, s96
  buffer_load_dwordx4 v[212:215], v28, s[72:75], s23 offen nt
  s_add_u32 s23, s23, s96
  buffer_load_dwordx4 v[216:219], v28, s[72:75], s23 offen nt
  s_add_u32 s23, s23, s96
  buffer_load_dwordx4 v[220:223], v28, s[72:75], s23 offen nt
  s_sub_u32 s23, s23, 53248
  v_mov_b32_dpp v16, v64 row_ror:8 row_mask:0xf bank_mask:0xf
  v_mov_b32_dpp v17, v65 row_ror:8 row_mask:0xf bank_mask:0xf
  v_mov_b32_dpp v18, v68 row_ror:8 row_mask:0xf bank_mask:0xf
  v_mov_b32_dpp v19, v69 row_ror:8 row_mask:0xf bank_mask:0xf
  v_mov_b32_dpp v64, v66 row_ror:8 row_mask:0xf bank_mask:0xc
  v_mov_b32_dpp v65, v67 row_ror:8 row_mask:0xf bank_mask:0xc
  v_mov_b32_dpp v68, v70 row_ror:8 row_mask:0xf bank_mask:0xc
  v_mov_b32_dpp v69, v71 row_ror:8 row_mask:0xf bank_mask:0xc
  v_mov_b32_dpp v66, v16 quad_perm:[0,1,2,3] row_mask:0xf bank_mask:0x3
  v_mov_b32_dpp v67, v17 quad_perm:[0,1,2,3] row_mask:0xf bank_mask:0x3
  v_mov_b32_dpp v70, v18 quad_perm:[0,1,2,3] row_mask:0xf bank_mask:0x3
  v_mov_b32_dpp v71, v19 quad_perm:[0,1,2,3] row_mask:0xf bank_mask:0x3
  v_mov_b32_dpp v16, v72 row_ror:8 row_mask:0xf bank_mask:0xf
  v_mov_b32_dpp v17, v73 row_ror:8 row_mask:0xf bank_mask:0xf
  v_mov_b32_dpp v18, v76 row_ror:8 row_mask:0xf bank_mask:0xf
  v_mov_b32_dpp v19, v77 row_ror:8 row_mask:0xf bank_mask:0xf
  v_mov_b32_dpp v72, v74 row_ror:8 row_mask:0xf bank_mask:0xc
  v_mov_b32_dpp v73, v75 row_ror:8 row_mask:0xf bank_mask:0xc
  v_mov_b32_dpp v76, v78 row_ror:8 row_mask:0xf bank_mask:0xc
  v_mov_b32_dpp v77, v79 row_ror:8 row_mask:0xf bank_mask:0xc
  v_mov_b32_dpp v74, v16 quad_perm:[0,1,2,3] row_mask:0xf bank_mask:0x3
  v_mov_b32_dpp v75, v17 quad_perm:[0,1,2,3] row_mask:0xf bank_mask:0x3
  v_mov_b32_dpp v78, v18 quad_perm:[0,1,2,3] row_mask:0xf bank_mask:0x3
  v_mov_b32_dpp v79, v19 quad_perm:[0,1,2,3] row_mask:0xf bank_mask:0x3
  v_mov_b32_dpp v16, v80 row_ror:8 row_mask:0xf bank_mask:0xf
  v_mov_b32_dpp v17, v81 row_ror:8 row_mask:0xf bank_mask:0xf
  v_mov_b32_dpp v18, v84 row_ror:8 row_mask:0xf bank_mask:0xf
  v_mov_b32_dpp v19, v85 row_ror:8 row_mask:0xf bank_mask:0xf
  v_mov_b32_dpp v80, v82 row_ror:8 row_mask:0xf bank_mask:0xc
  v_mov_b32_dpp v81, v83 row_ror:8 row_mask:0xf bank_mask:0xc
  v_mov_b32_dpp v84, v86 row_ror:8 row_mask:0xf bank_mask:0xc
  v_mov_b32_dpp v85, v87 row_ror:8 row_mask:0xf bank_mask:0xc
  v_mov_b32_dpp v82, v16 quad_perm:[0,1,2,3] row_mask:0xf bank_mask:0x3
  v_mov_b32_dpp v83, v17 quad_perm:[0,1,2,3] row_mask:0xf bank_mask:0x3
  v_mov_b32_dpp v86, v18 quad_perm:[0,1,2,3] row_mask:0xf bank_mask:0x3
  v_mov_b32_dpp v87, v19 quad_perm:[0,1,2,3] row_mask:0xf bank_mask:0x3
  v_mov_b32_dpp v16, v88 row_ror:8 row_mask:0xf bank_mask:0xf
  v_mov_b32_dpp v17, v89 row_ror:8 row_mask:0xf bank_mask:0xf
  v_mov_b32_dpp v18, v92 row_ror:8 row_mask:0xf bank_mask:0xf
  v_mov_b32_dpp v19, v93 row_ror:8 row_mask:0xf bank_mask:0xf
  v_mov_b32_dpp v88, v90 row_ror:8 row_mask:0xf bank_mask:0xc
  v_mov_b32_dpp v89, v91 row_ror:8 row_mask:0xf bank_mask:0xc
  v_mov_b32_dpp v92, v94 row_ror:8 row_mask:0xf bank_mask:0xc
  v_mov_b32_dpp v93, v95 row_ror:8 row_mask:0xf bank_mask:0xc
  v_mov_b32_dpp v90, v16 quad_perm:[0,1,2,3] row_mask:0xf bank_mask:0x3
  v_mov_b32_dpp v91, v17 quad_perm:[0,1,2,3] row_mask:0xf bank_mask:0x3
  v_mov_b32_dpp v94, v18 quad_perm:[0,1,2,3] row_mask:0xf bank_mask:0x3
  v_mov_b32_dpp v95, v19 quad_perm:[0,1,2,3] row_mask:0xf bank_mask:0x3
  v_perm_b32 v16, v68, v64, s27
  v_perm_b32 v17, v76, v72, s27
  v_perm_b32 v18, v84, v80, s27
  v_perm_b32 v19, v92, v88, s27
  v_perm_b32 v20, v68, v64, s28
  v_perm_b32 v21, v76, v72, s28
  v_perm_b32 v22, v84, v80, s28
  v_perm_b32 v23, v92, v88, s28
  v_mfma_f32_16x16x32_bf16 v[32:35], v[48:51], v[16:19], 0
  v_perm_b32 v24, v69, v65, s27
  v_perm_b32 v25, v77, v73, s27
  v_perm_b32 v26, v85, v81, s27
  v_perm_b32 v27, v93, v89, s27
  v_mfma_f32_16x16x32_bf16 v[36:39], v[48:51], v[20:23], 0
  v_perm_b32 v16, v69, v65, s28
  v_perm_b32 v17, v77, v73, s28
  v_perm_b32 v18, v85, v81, s28
  v_perm_b32 v19, v93, v89, s28
  v_mfma_f32_16x16x32_bf16 v[40:43], v[48:51], v[24:27], 0
  v_perm_b32 v20, v70, v66, s27
  v_perm_b32 v21, v78, v74, s27
  v_perm_b32 v22, v86, v82, s27
  v_perm_b32 v23, v94, v90, s27
  v_mfma_f32_16x16x32_bf16 v[44:47], v[48:51], v[16:19], 0
  v_perm_b32 v24, v70, v66, s28
  v_perm_b32 v25, v78, v74, s28
  v_perm_b32 v26, v86, v82, s28
  v_perm_b32 v27, v94, v90, s28
  v_mfma_f32_16x16x32_bf16 v[32:35], v[52:55], v[20:23], v[32:35]
  v_perm_b32 v16, v71, v67, s27
  v_perm_b32 v17, v79, v75, s27
  v_perm_b32 v18, v87, v83, s27
  v_perm_b32 v19, v95, v91, s27
  v_mfma_f32_16x16x32_bf16 v[36:39], v[52:55], v[24:27], v[36:39]
  v_perm_b32 v20, v71, v67, s28
  v_perm_b32 v21, v79, v75, s28
  v_perm_b32 v22, v87, v83, s28
  v_perm_b32 v23, v95, v91, s28
  v_mfma_f32_16x16x32_bf16 v[40:43], v[52:55], v[16:19], v[40:43]
  s_nop 0
  v_mfma_f32_16x16x32_bf16 v[44:47], v[52:55], v[20:23], v[44:47]
  s_mov_b64 exec, 0xffff
  ds_write_b128 v9, v[32:35] offset:0
  ds_write_b128 v9, v[36:39] offset:256
  s_nop 2
  ds_write_b128 v9, v[40:43] offset:512
  s_nop 0
  ds_write_b128 v9, v[44:47] offset:768
  s_mov_b64 exec, -1
  v_and_b32 v104, 3, v2
  v_lshlrev_b32 v104, 2, v104
  v_lshrrev_b32 v29, 2, v2
  v_add_u32 v104, v104, v29
  v_lshl_add_u32 v7, v104, 1, v7
  s_lshl_b32 s26, s20, 5
  v_mov_b32 v104, 0
  ds_write_b32 v104, v104 offset:26616
  s_waitcnt vmcnt(8)
  s_waitcnt lgkmcnt(0)
  s_barrier
  s_cmp_lg_u32 s3, 1
  s_cbranch_scc1 L_ns37
  v_mov_b32 v29, s10
  s_mov_b64 exec, 1
  buffer_atomic_add v29, off, s[16:19], 0 offset:0 sc1
  s_mov_b64 exec, -1
L_ns37:
  s_cmp_lg_u32 s3, 0
  s_cbranch_scc1 L_wts38
  ds_read2st64_b32 v[64:65], v10 offset0:0 offset1:1
  ds_read2st64_b32 v[66:67], v10 offset0:2 offset1:3
  ds_read2st64_b32 v[68:69], v10 offset0:8 offset1:9
  ds_read2st64_b32 v[70:71], v10 offset0:10 offset1:11
  ds_read2st64_b32 v[72:73], v10 offset0:16 offset1:17
  ds_read2st64_b32 v[74:75], v10 offset0:18 offset1:19
  ds_read2st64_b32 v[76:77], v10 offset0:24 offset1:25
  ds_read2st64_b32 v[78:79], v10 offset0:26 offset1:27
  ds_read2st64_b32 v[80:81], v10 offset0:32 offset1:33
  ds_read2st64_b32 v[82:83], v10 offset0:34 offset1:35
  ds_read2st64_b32 v[84:85], v10 offset0:40 offset1:41
  ds_read2st64_b32 v[86:87], v10 offset0:42 offset1:43
  ds_read2st64_b32 v[88:89], v10 offset0:48 offset1:49
  ds_read2st64_b32 v[90:91], v10 offset0:50 offset1:51
  ds_read2st64_b32 v[92:93], v10 offset0:56 offset1:57
  ds_read2st64_b32 v[94:95], v10 offset0:58 offset1:59
  s_waitcnt lgkmcnt(0)
  v_add_f32 v64, v64, v68
  v_add_f32 v65, v65, v69
  v_add_f32 v66, v66, v70
  v_add_f32 v67, v67, v71
  v_add_f32 v72, v72, v76
  v_add_f32 v73, v73, v77
  v_add_f32 v74, v74, v78
  v_add_f32 v75, v75, v79
  v_add_f32 v80, v80, v84
  v_add_f32 v81, v81, v85
  v_add_f32 v82, v82, v86
  v_add_f32 v83, v83, v87
  v_add_f32 v88, v88, v92
  v_add_f32 v89, v89, v93
  v_add_f32 v90, v90, v94
  v_add_f32 v91, v91, v95
  v_add_f32 v64, v64, v72
  v_add_f32 v65, v65, v73
  v_add_f32 v66, v66, v74
  v_add_f32 v67, v67, v75
  v_add_f32 v80, v80, v88
  v_add_f32 v81, v81, v89
  v_add_f32 v82, v82, v90
  v_add_f32 v83, v83, v91
  v_add_f32 v64, v64, v80
  v_add_f32 v65, v65, v81
  v_add_f32 v66, v66, v82
  v_add_f32 v67, v67, v83
  v_cvt_pk_bf16_f32 v64, v64, v65
  v_cvt_pk_bf16_f32 v65, v66, v67
  v_mov_b32 v29, 132
  s_mov_b32 s31, 0
  s_branch L_pfc41
L_pf39:
  buffer_load_dword v30, v29, s[16:19], 0 offen sc1
  s_waitcnt vmcnt(0)
L_pfc41:
  v_cmp_gt_u32 vcc, 0x40000000, v30
  s_cbranch_vccz L_pfd40
  s_add_u32 s31, s31, 1
  s_cmp_ge_u32 s31, 131072
  s_cbranch_scc1 L_pfd40
  s_sleep 2
  s_branch L_pf39
L_pfd40:
  s_lshr_b32 s24, s98, 3
  s_lshl_b32 s24, s24, 12
  s_and_b32 s94, s98, 7
  s_lshl_b32 s94, s94, 7
  s_add_u32 s24, s24, s94
  s_add_u32 s24, s24, 24576
  buffer_store_dwordx2 v[64:65], v5, s[12:15], s24 offen sc1
L_wts38:
  buffer_load_ushort v102, v7, s[88:91], s26 offen
  s_waitcnt vmcnt(5)
  buffer_load_dwordx4 v[224:227], v28, s[72:75], s23 offen nt
  s_add_u32 s23, s23, s96
  s_waitcnt vmcnt(5)
  buffer_load_dwordx4 v[228:231], v28, s[72:75], s23 offen nt
  s_add_u32 s23, s23, s96
  s_waitcnt vmcnt(5)
  buffer_load_dwordx4 v[232:235], v28, s[72:75], s23 offen nt
  s_add_u32 s23, s23, s96
  s_waitcnt vmcnt(5)
  buffer_load_dwordx4 v[236:239], v28, s[72:75], s23 offen nt
  s_add_u32 s23, s23, s96
  s_waitcnt vmcnt(5)
  buffer_load_dwordx4 v[240:243], v28, s[72:75], s23 offen nt
  s_add_u32 s23, s23, s96
  s_waitcnt vmcnt(5)
  buffer_load_dwordx4 v[244:247], v28, s[72:75], s23 offen nt
  s_add_u32 s23, s23, s96
  s_waitcnt vmcnt(5)
  buffer_load_dwordx4 v[248:251], v28, s[72:75], s23 offen nt
  s_add_u32 s23, s23, s96
  s_waitcnt vmcnt(5)
  buffer_load_dwordx4 v[252:255], v28, s[72:75], s23 offen nt
  s_waitcnt vmcnt(5)
  s_mov_b32 s76, s48
  s_mov_b32 s77, s49
  s_mov_b32 s78, 0x1c0000
  s_mov_b32 s79, 0x20000
  s_mov_b32 s80, s50
  s_mov_b32 s81, s51
  s_mov_b32 s82, 0x1c0000
  s_mov_b32 s83, 0x20000
  s_mov_b32 s84, s52
  s_mov_b32 s85, s53
  s_mov_b32 s86, 0x1c0000
  s_mov_b32 s87, 0x20000
  s_cmp_lt_u32 s20, 28
  s_cselect_b32 s78, s78, 0
  s_cselect_b32 s82, s82, 0
  s_cselect_b32 s86, s86, 0
  v_lshrrev_b32 v15, 1, v3
  v_lshlrev_b32 v15, 3, v15
  v_and_b32 v4, 1, v3
  v_add_u32 v15, v15, v4
  v_lshl_add_u32 v15, v6, 1, v15
  v_mul_u32_u24 v15, 7168, v15
  v_add_u32 v15, v15, v11
  s_mul_i32 s22, s3, 229376
  s_lshl_b32 s24, s20, 7
  s_add_u32 s22, s22, s24
  s_add_u32 s24, s22, 0
  buffer_load_dwordx4 v[32:35], v15, s[76:79], s24 offen nt
  s_waitcnt vmcnt(5)
  s_add_u32 s24, s22, 14336
  buffer_load_dwordx4 v[36:39], v15, s[76:79], s24 offen nt
  s_waitcnt vmcnt(5)
  s_add_u32 s24, s22, 28672
  buffer_load_dwordx4 v[40:43], v15, s[76:79], s24 offen nt
  s_waitcnt vmcnt(5)
  s_add_u32 s24, s22, 43008
  buffer_load_dwordx4 v[44:47], v15, s[76:79], s24 offen nt
  s_waitcnt vmcnt(5)
  s_add_u32 s24, s22, 3584
  buffer_load_dwordx4 v[48:51], v15, s[76:79], s24 offen nt
  s_waitcnt vmcnt(5)
  s_add_u32 s24, s22, 17920
  buffer_load_dwordx4 v[52:55], v15, s[76:79], s24 offen nt
  s_add_u32 s24, s22, 32256
  buffer_load_dwordx4 v[56:59], v15, s[76:79], s24 offen nt
  s_add_u32 s24, s22, 46592
  buffer_load_dwordx4 v[60:63], v15, s[76:79], s24 offen nt
  s_add_u32 s24, s22, 0
  buffer_load_dwordx4 v[64:67], v15, s[80:83], s24 offen nt
  v_mov_b32_dpp v16, v192 row_ror:8 row_mask:0xf bank_mask:0xf
  v_mov_b32_dpp v17, v193 row_ror:8 row_mask:0xf bank_mask:0xf
  v_mov_b32_dpp v18, v196 row_ror:8 row_mask:0xf bank_mask:0xf
  v_mov_b32_dpp v19, v197 row_ror:8 row_mask:0xf bank_mask:0xf
  v_mov_b32_dpp v192, v194 row_ror:8 row_mask:0xf bank_mask:0xc
  v_mov_b32_dpp v193, v195 row_ror:8 row_mask:0xf bank_mask:0xc
  v_mov_b32_dpp v196, v198 row_ror:8 row_mask:0xf bank_mask:0xc
  v_mov_b32_dpp v197, v199 row_ror:8 row_mask:0xf bank_mask:0xc
  v_mov_b32_dpp v194, v16 quad_perm:[0,1,2,3] row_mask:0xf bank_mask:0x3
  v_mov_b32_dpp v195, v17 quad_perm:[0,1,2,3] row_mask:0xf bank_mask:0x3
  v_mov_b32_dpp v198, v18 quad_perm:[0,1,2,3] row_mask:0xf bank_mask:0x3
  v_mov_b32_dpp v199, v19 quad_perm:[0,1,2,3] row_mask:0xf bank_mask:0x3
  v_mov_b32_dpp v16, v200 row_ror:8 row_mask:0xf bank_mask:0xf
  v_mov_b32_dpp v17, v201 row_ror:8 row_mask:0xf bank_mask:0xf
  v_mov_b32_dpp v18, v204 row_ror:8 row_mask:0xf bank_mask:0xf
  v_mov_b32_dpp v19, v205 row_ror:8 row_mask:0xf bank_mask:0xf
  v_mov_b32_dpp v200, v202 row_ror:8 row_mask:0xf bank_mask:0xc
  v_mov_b32_dpp v201, v203 row_ror:8 row_mask:0xf bank_mask:0xc
  v_mov_b32_dpp v204, v206 row_ror:8 row_mask:0xf bank_mask:0xc
  v_mov_b32_dpp v205, v207 row_ror:8 row_mask:0xf bank_mask:0xc
  v_mov_b32_dpp v202, v16 quad_perm:[0,1,2,3] row_mask:0xf bank_mask:0x3
  v_mov_b32_dpp v203, v17 quad_perm:[0,1,2,3] row_mask:0xf bank_mask:0x3
  v_mov_b32_dpp v206, v18 quad_perm:[0,1,2,3] row_mask:0xf bank_mask:0x3
  v_mov_b32_dpp v207, v19 quad_perm:[0,1,2,3] row_mask:0xf bank_mask:0x3
  v_mov_b32_dpp v16, v208 row_ror:8 row_mask:0xf bank_mask:0xf
  v_mov_b32_dpp v17, v209 row_ror:8 row_mask:0xf bank_mask:0xf
  v_mov_b32_dpp v18, v212 row_ror:8 row_mask:0xf bank_mask:0xf
  v_mov_b32_dpp v19, v213 row_ror:8 row_mask:0xf bank_mask:0xf
  v_mov_b32_dpp v208, v210 row_ror:8 row_mask:0xf bank_mask:0xc
  v_mov_b32_dpp v209, v211 row_ror:8 row_mask:0xf bank_mask:0xc
  v_mov_b32_dpp v212, v214 row_ror:8 row_mask:0xf bank_mask:0xc
  v_mov_b32_dpp v213, v215 row_ror:8 row_mask:0xf bank_mask:0xc
  v_mov_b32_dpp v210, v16 quad_perm:[0,1,2,3] row_mask:0xf bank_mask:0x3
  v_mov_b32_dpp v211, v17 quad_perm:[0,1,2,3] row_mask:0xf bank_mask:0x3
  v_mov_b32_dpp v214, v18 quad_perm:[0,1,2,3] row_mask:0xf bank_mask:0x3
  v_mov_b32_dpp v215, v19 quad_perm:[0,1,2,3] row_mask:0xf bank_mask:0x3
  v_mov_b32_dpp v16, v216 row_ror:8 row_mask:0xf bank_mask:0xf
  v_mov_b32_dpp v17, v217 row_ror:8 row_mask:0xf bank_mask:0xf
  v_mov_b32_dpp v18, v220 row_ror:8 row_mask:0xf bank_mask:0xf
  v_mov_b32_dpp v19, v221 row_ror:8 row_mask:0xf bank_mask:0xf
  v_mov_b32_dpp v216, v218 row_ror:8 row_mask:0xf bank_mask:0xc
  v_mov_b32_dpp v217, v219 row_ror:8 row_mask:0xf bank_mask:0xc
  v_mov_b32_dpp v220, v222 row_ror:8 row_mask:0xf bank_mask:0xc
  v_mov_b32_dpp v221, v223 row_ror:8 row_mask:0xf bank_mask:0xc
  v_mov_b32_dpp v218, v16 quad_perm:[0,1,2,3] row_mask:0xf bank_mask:0x3
  v_mov_b32_dpp v219, v17 quad_perm:[0,1,2,3] row_mask:0xf bank_mask:0x3
  v_mov_b32_dpp v222, v18 quad_perm:[0,1,2,3] row_mask:0xf bank_mask:0x3
  v_mov_b32_dpp v223, v19 quad_perm:[0,1,2,3] row_mask:0xf bank_mask:0x3
  v_mov_b32_dpp v16, v224 row_ror:8 row_mask:0xf bank_mask:0xf
  v_mov_b32_dpp v17, v225 row_ror:8 row_mask:0xf bank_mask:0xf
  v_mov_b32_dpp v18, v228 row_ror:8 row_mask:0xf bank_mask:0xf
  v_mov_b32_dpp v19, v229 row_ror:8 row_mask:0xf bank_mask:0xf
  v_mov_b32_dpp v224, v226 row_ror:8 row_mask:0xf bank_mask:0xc
  v_mov_b32_dpp v225, v227 row_ror:8 row_mask:0xf bank_mask:0xc
  v_mov_b32_dpp v228, v230 row_ror:8 row_mask:0xf bank_mask:0xc
  v_mov_b32_dpp v229, v231 row_ror:8 row_mask:0xf bank_mask:0xc
  v_mov_b32_dpp v226, v16 quad_perm:[0,1,2,3] row_mask:0xf bank_mask:0x3
  v_mov_b32_dpp v227, v17 quad_perm:[0,1,2,3] row_mask:0xf bank_mask:0x3
  v_mov_b32_dpp v230, v18 quad_perm:[0,1,2,3] row_mask:0xf bank_mask:0x3
  v_mov_b32_dpp v231, v19 quad_perm:[0,1,2,3] row_mask:0xf bank_mask:0x3
  v_mov_b32_dpp v16, v232 row_ror:8 row_mask:0xf bank_mask:0xf
  v_mov_b32_dpp v17, v233 row_ror:8 row_mask:0xf bank_mask:0xf
  v_mov_b32_dpp v18, v236 row_ror:8 row_mask:0xf bank_mask:0xf
  v_mov_b32_dpp v19, v237 row_ror:8 row_mask:0xf bank_mask:0xf
  v_mov_b32_dpp v232, v234 row_ror:8 row_mask:0xf bank_mask:0xc
  v_mov_b32_dpp v233, v235 row_ror:8 row_mask:0xf bank_mask:0xc
  v_mov_b32_dpp v236, v238 row_ror:8 row_mask:0xf bank_mask:0xc
  v_mov_b32_dpp v237, v239 row_ror:8 row_mask:0xf bank_mask:0xc
  v_mov_b32_dpp v234, v16 quad_perm:[0,1,2,3] row_mask:0xf bank_mask:0x3
  v_mov_b32_dpp v235, v17 quad_perm:[0,1,2,3] row_mask:0xf bank_mask:0x3
  v_mov_b32_dpp v238, v18 quad_perm:[0,1,2,3] row_mask:0xf bank_mask:0x3
  v_mov_b32_dpp v239, v19 quad_perm:[0,1,2,3] row_mask:0xf bank_mask:0x3
  v_mov_b32_dpp v16, v240 row_ror:8 row_mask:0xf bank_mask:0xf
  v_mov_b32_dpp v17, v241 row_ror:8 row_mask:0xf bank_mask:0xf
  v_mov_b32_dpp v18, v244 row_ror:8 row_mask:0xf bank_mask:0xf
  v_mov_b32_dpp v19, v245 row_ror:8 row_mask:0xf bank_mask:0xf
  v_mov_b32_dpp v240, v242 row_ror:8 row_mask:0xf bank_mask:0xc
  v_mov_b32_dpp v241, v243 row_ror:8 row_mask:0xf bank_mask:0xc
  v_mov_b32_dpp v244, v246 row_ror:8 row_mask:0xf bank_mask:0xc
  v_mov_b32_dpp v245, v247 row_ror:8 row_mask:0xf bank_mask:0xc
  v_mov_b32_dpp v242, v16 quad_perm:[0,1,2,3] row_mask:0xf bank_mask:0x3
  v_mov_b32_dpp v243, v17 quad_perm:[0,1,2,3] row_mask:0xf bank_mask:0x3
  v_mov_b32_dpp v246, v18 quad_perm:[0,1,2,3] row_mask:0xf bank_mask:0x3
  v_mov_b32_dpp v247, v19 quad_perm:[0,1,2,3] row_mask:0xf bank_mask:0x3
  v_mov_b32_dpp v16, v248 row_ror:8 row_mask:0xf bank_mask:0xf
  v_mov_b32_dpp v17, v249 row_ror:8 row_mask:0xf bank_mask:0xf
  v_mov_b32_dpp v18, v252 row_ror:8 row_mask:0xf bank_mask:0xf
  v_mov_b32_dpp v19, v253 row_ror:8 row_mask:0xf bank_mask:0xf
  v_mov_b32_dpp v248, v250 row_ror:8 row_mask:0xf bank_mask:0xc
  v_mov_b32_dpp v249, v251 row_ror:8 row_mask:0xf bank_mask:0xc
  v_mov_b32_dpp v252, v254 row_ror:8 row_mask:0xf bank_mask:0xc
  v_mov_b32_dpp v253, v255 row_ror:8 row_mask:0xf bank_mask:0xc
  v_mov_b32_dpp v250, v16 quad_perm:[0,1,2,3] row_mask:0xf bank_mask:0x3
  v_mov_b32_dpp v251, v17 quad_perm:[0,1,2,3] row_mask:0xf bank_mask:0x3
  v_mov_b32_dpp v254, v18 quad_perm:[0,1,2,3] row_mask:0xf bank_mask:0x3
  v_mov_b32_dpp v255, v19 quad_perm:[0,1,2,3] row_mask:0xf bank_mask:0x3
  v_perm_b32 v104, v196, v192, s27
  v_perm_b32 v105, v204, v200, s27
  v_perm_b32 v106, v212, v208, s27
  v_perm_b32 v107, v220, v216, s27
  v_perm_b32 v108, v196, v192, s28
  v_perm_b32 v109, v204, v200, s28
  v_perm_b32 v110, v212, v208, s28
  v_perm_b32 v111, v220, v216, s28
  v_perm_b32 v112, v197, v193, s27
  v_perm_b32 v113, v205, v201, s27
  v_perm_b32 v114, v213, v209, s27
  v_perm_b32 v115, v221, v217, s27
  v_perm_b32 v116, v197, v193, s28
  v_perm_b32 v117, v205, v201, s28
  v_perm_b32 v118, v213, v209, s28
  v_perm_b32 v119, v221, v217, s28
  v_perm_b32 v120, v198, v194, s27
  v_perm_b32 v121, v206, v202, s27
  v_perm_b32 v122, v214, v210, s27
  v_perm_b32 v123, v222, v218, s27
  v_perm_b32 v124, v198, v194, s28
  v_perm_b32 v125, v206, v202, s28
  v_perm_b32 v126, v214, v210, s28
  v_perm_b32 v127, v222, v218, s28
  v_perm_b32 v128, v199, v195, s27
  v_perm_b32 v129, v207, v203, s27
  v_perm_b32 v130, v215, v211, s27
  v_perm_b32 v131, v223, v219, s27
  v_perm_b32 v132, v199, v195, s28
  v_perm_b32 v133, v207, v203, s28
  v_perm_b32 v134, v215, v211, s28
  v_perm_b32 v135, v223, v219, s28
  v_perm_b32 v136, v228, v224, s27
  v_perm_b32 v137, v236, v232, s27
  v_perm_b32 v138, v244, v240, s27
  v_perm_b32 v139, v252, v248, s27
  v_perm_b32 v140, v228, v224, s28
  v_perm_b32 v141, v236, v232, s28
  v_perm_b32 v142, v244, v240, s28
  v_perm_b32 v143, v252, v248, s28
  v_perm_b32 v144, v229, v225, s27
  v_perm_b32 v145, v237, v233, s27
  v_perm_b32 v146, v245, v241, s27
  v_perm_b32 v147, v253, v249, s27
  v_perm_b32 v148, v229, v225, s28
  v_perm_b32 v149, v237, v233, s28
  v_perm_b32 v150, v245, v241, s28
  v_perm_b32 v151, v253, v249, s28
  v_perm_b32 v152, v230, v226, s27
  v_perm_b32 v153, v238, v234, s27
  v_perm_b32 v154, v246, v242, s27
  v_perm_b32 v155, v254, v250, s27
  v_perm_b32 v156, v230, v226, s28
  v_perm_b32 v157, v238, v234, s28
  v_perm_b32 v158, v246, v242, s28
  v_perm_b32 v159, v254, v250, s28
  v_perm_b32 v160, v231, v227, s27
  v_perm_b32 v161, v239, v235, s27
  v_perm_b32 v162, v247, v243, s27
  v_perm_b32 v163, v255, v251, s27
  v_perm_b32 v164, v231, v227, s28
  v_perm_b32 v165, v239, v235, s28
  v_perm_b32 v166, v247, v243, s28
  v_perm_b32 v167, v255, v251, s28
  s_waitcnt vmcnt(5)
  s_add_u32 s24, s22, 14336
  buffer_load_dwordx4 v[68:71], v15, s[80:83], s24 offen nt
  s_waitcnt vmcnt(5)
  s_add_u32 s24, s22, 28672
  buffer_load_dwordx4 v[72:75], v15, s[80:83], s24 offen nt
  s_waitcnt vmcnt(5)
  s_add_u32 s24, s22, 43008
  buffer_load_dwordx4 v[76:79], v15, s[80:83], s24 offen nt
  s_waitcnt vmcnt(5)
  s_add_u32 s24, s22, 3584
  buffer_load_dwordx4 v[80:83], v15, s[80:83], s24 offen nt
  s_waitcnt vmcnt(5)
  s_add_u32 s24, s22, 17920
  buffer_load_dwordx4 v[84:87], v15, s[80:83], s24 offen nt
  s_waitcnt vmcnt(5)
  s_add_u32 s24, s22, 32256
  buffer_load_dwordx4 v[88:91], v15, s[80:83], s24 offen nt
  s_waitcnt vmcnt(5)
  s_add_u32 s24, s22, 46592
  buffer_load_dwordx4 v[92:95], v15, s[80:83], s24 offen nt
  buffer_load_dword v30, off, s[16:19], 0 offset:0 sc1
  s_waitcnt vmcnt(5)
  v_lshl_add_u32 v4, v6, 12, v11
  v_lshl_add_u32 v4, v3, 13, v4
  s_lshl_b32 s23, s20, 16
  s_add_u32 s23, s23, s29
  buffer_load_dwordx4 v[200:203], v4, s[84:87], s23 offen offset:0 nt
  s_waitcnt vmcnt(5)
  buffer_load_dwordx4 v[204:207], v4, s[84:87], s23 offen offset:1024 nt
  s_waitcnt vmcnt(5)
  buffer_load_dwordx4 v[208:211], v4, s[84:87], s23 offen offset:2048 nt
  s_waitcnt vmcnt(5)
  buffer_load_dwordx4 v[212:215], v4, s[84:87], s23 offen offset:3072 nt
  s_waitcnt vmcnt(5)
  s_add_u32 s23, s23, 4096
  buffer_load_dwordx4 v[216:219], v4, s[84:87], s23 offen offset:0 nt
  s_waitcnt vmcnt(5)
  buffer_load_dwordx4 v[220:223], v4, s[84:87], s23 offen offset:1024 nt
  s_waitcnt vmcnt(5)
  buffer_load_dwordx4 v[224:227], v4, s[84:87], s23 offen offset:2048 nt
  s_waitcnt vmcnt(5)
  buffer_load_dwordx4 v[228:231], v4, s[84:87], s23 offen offset:3072 nt
  v_mov_b32_dpp v16, v32 row_ror:8 row_mask:0xf bank_mask:0xf
  v_mov_b32_dpp v17, v33 row_ror:8 row_mask:0xf bank_mask:0xf
  v_mov_b32_dpp v18, v34 row_ror:8 row_mask:0xf bank_mask:0xf
  v_mov_b32_dpp v19, v35 row_ror:8 row_mask:0xf bank_mask:0xf
  v_mov_b32_dpp v32, v64 row_ror:8 row_mask:0xf bank_mask:0xc
  v_mov_b32_dpp v33, v65 row_ror:8 row_mask:0xf bank_mask:0xc
  v_mov_b32_dpp v34, v66 row_ror:8 row_mask:0xf bank_mask:0xc
  v_mov_b32_dpp v35, v67 row_ror:8 row_mask:0xf bank_mask:0xc
  v_mov_b32_dpp v64, v16 quad_perm:[0,1,2,3] row_mask:0xf bank_mask:0x3
  v_mov_b32_dpp v65, v17 quad_perm:[0,1,2,3] row_mask:0xf bank_mask:0x3
  v_mov_b32_dpp v66, v18 quad_perm:[0,1,2,3] row_mask:0xf bank_mask:0x3
  v_mov_b32_dpp v67, v19 quad_perm:[0,1,2,3] row_mask:0xf bank_mask:0x3
  v_mov_b32_dpp v16, v36 row_ror:8 row_mask:0xf bank_mask:0xf
  v_mov_b32_dpp v17, v37 row_ror:8 row_mask:0xf bank_mask:0xf
  v_mov_b32_dpp v18, v38 row_ror:8 row_mask:0xf bank_mask:0xf
  v_mov_b32_dpp v19, v39 row_ror:8 row_mask:0xf bank_mask:0xf
  v_mov_b32_dpp v36, v68 row_ror:8 row_mask:0xf bank_mask:0xc
  v_mov_b32_dpp v37, v69 row_ror:8 row_mask:0xf bank_mask:0xc
  v_mov_b32_dpp v38, v70 row_ror:8 row_mask:0xf bank_mask:0xc
  v_mov_b32_dpp v39, v71 row_ror:8 row_mask:0xf bank_mask:0xc
  v_mov_b32_dpp v68, v16 quad_perm:[0,1,2,3] row_mask:0xf bank_mask:0x3
  v_mov_b32_dpp v69, v17 quad_perm:[0,1,2,3] row_mask:0xf bank_mask:0x3
  v_mov_b32_dpp v70, v18 quad_perm:[0,1,2,3] row_mask:0xf bank_mask:0x3
  v_mov_b32_dpp v71, v19 quad_perm:[0,1,2,3] row_mask:0xf bank_mask:0x3
  v_mov_b32_dpp v16, v40 row_ror:8 row_mask:0xf bank_mask:0xf
  v_mov_b32_dpp v17, v41 row_ror:8 row_mask:0xf bank_mask:0xf
  v_mov_b32_dpp v18, v42 row_ror:8 row_mask:0xf bank_mask:0xf
  v_mov_b32_dpp v19, v43 row_ror:8 row_mask:0xf bank_mask:0xf
  v_mov_b32_dpp v40, v72 row_ror:8 row_mask:0xf bank_mask:0xc
  v_mov_b32_dpp v41, v73 row_ror:8 row_mask:0xf bank_mask:0xc
  v_mov_b32_dpp v42, v74 row_ror:8 row_mask:0xf bank_mask:0xc
  v_mov_b32_dpp v43, v75 row_ror:8 row_mask:0xf bank_mask:0xc
  v_mov_b32_dpp v72, v16 quad_perm:[0,1,2,3] row_mask:0xf bank_mask:0x3
  v_mov_b32_dpp v73, v17 quad_perm:[0,1,2,3] row_mask:0xf bank_mask:0x3
  v_mov_b32_dpp v74, v18 quad_perm:[0,1,2,3] row_mask:0xf bank_mask:0x3
  v_mov_b32_dpp v75, v19 quad_perm:[0,1,2,3] row_mask:0xf bank_mask:0x3
  v_mov_b32_dpp v16, v44 row_ror:8 row_mask:0xf bank_mask:0xf
  v_mov_b32_dpp v17, v45 row_ror:8 row_mask:0xf bank_mask:0xf
  v_mov_b32_dpp v18, v46 row_ror:8 row_mask:0xf bank_mask:0xf
  v_mov_b32_dpp v19, v47 row_ror:8 row_mask:0xf bank_mask:0xf
  v_mov_b32_dpp v44, v76 row_ror:8 row_mask:0xf bank_mask:0xc
  v_mov_b32_dpp v45, v77 row_ror:8 row_mask:0xf bank_mask:0xc
  v_mov_b32_dpp v46, v78 row_ror:8 row_mask:0xf bank_mask:0xc
  v_mov_b32_dpp v47, v79 row_ror:8 row_mask:0xf bank_mask:0xc
  v_mov_b32_dpp v76, v16 quad_perm:[0,1,2,3] row_mask:0xf bank_mask:0x3
  v_mov_b32_dpp v77, v17 quad_perm:[0,1,2,3] row_mask:0xf bank_mask:0x3
  v_mov_b32_dpp v78, v18 quad_perm:[0,1,2,3] row_mask:0xf bank_mask:0x3
  v_mov_b32_dpp v79, v19 quad_perm:[0,1,2,3] row_mask:0xf bank_mask:0x3
  v_mov_b32_dpp v16, v48 row_ror:8 row_mask:0xf bank_mask:0xf
  v_mov_b32_dpp v17, v49 row_ror:8 row_mask:0xf bank_mask:0xf
  v_mov_b32_dpp v18, v50 row_ror:8 row_mask:0xf bank_mask:0xf
  v_mov_b32_dpp v19, v51 row_ror:8 row_mask:0xf bank_mask:0xf
  v_mov_b32_dpp v48, v80 row_ror:8 row_mask:0xf bank_mask:0xc
  v_mov_b32_dpp v49, v81 row_ror:8 row_mask:0xf bank_mask:0xc
  v_mov_b32_dpp v50, v82 row_ror:8 row_mask:0xf bank_mask:0xc
  v_mov_b32_dpp v51, v83 row_ror:8 row_mask:0xf bank_mask:0xc
  v_mov_b32_dpp v80, v16 quad_perm:[0,1,2,3] row_mask:0xf bank_mask:0x3
  v_mov_b32_dpp v81, v17 quad_perm:[0,1,2,3] row_mask:0xf bank_mask:0x3
  v_mov_b32_dpp v82, v18 quad_perm:[0,1,2,3] row_mask:0xf bank_mask:0x3
  v_mov_b32_dpp v83, v19 quad_perm:[0,1,2,3] row_mask:0xf bank_mask:0x3
  v_mov_b32_dpp v16, v52 row_ror:8 row_mask:0xf bank_mask:0xf
  v_mov_b32_dpp v17, v53 row_ror:8 row_mask:0xf bank_mask:0xf
  v_mov_b32_dpp v18, v54 row_ror:8 row_mask:0xf bank_mask:0xf
  v_mov_b32_dpp v19, v55 row_ror:8 row_mask:0xf bank_mask:0xf
  v_mov_b32_dpp v52, v84 row_ror:8 row_mask:0xf bank_mask:0xc
  v_mov_b32_dpp v53, v85 row_ror:8 row_mask:0xf bank_mask:0xc
  v_mov_b32_dpp v54, v86 row_ror:8 row_mask:0xf bank_mask:0xc
  v_mov_b32_dpp v55, v87 row_ror:8 row_mask:0xf bank_mask:0xc
  v_mov_b32_dpp v84, v16 quad_perm:[0,1,2,3] row_mask:0xf bank_mask:0x3
  v_mov_b32_dpp v85, v17 quad_perm:[0,1,2,3] row_mask:0xf bank_mask:0x3
  v_mov_b32_dpp v86, v18 quad_perm:[0,1,2,3] row_mask:0xf bank_mask:0x3
  v_mov_b32_dpp v87, v19 quad_perm:[0,1,2,3] row_mask:0xf bank_mask:0x3
  v_mov_b32_dpp v16, v56 row_ror:8 row_mask:0xf bank_mask:0xf
  v_mov_b32_dpp v17, v57 row_ror:8 row_mask:0xf bank_mask:0xf
  v_mov_b32_dpp v18, v58 row_ror:8 row_mask:0xf bank_mask:0xf
  v_mov_b32_dpp v19, v59 row_ror:8 row_mask:0xf bank_mask:0xf
  v_mov_b32_dpp v56, v88 row_ror:8 row_mask:0xf bank_mask:0xc
  v_mov_b32_dpp v57, v89 row_ror:8 row_mask:0xf bank_mask:0xc
  v_mov_b32_dpp v58, v90 row_ror:8 row_mask:0xf bank_mask:0xc
  v_mov_b32_dpp v59, v91 row_ror:8 row_mask:0xf bank_mask:0xc
  v_mov_b32_dpp v88, v16 quad_perm:[0,1,2,3] row_mask:0xf bank_mask:0x3
  v_mov_b32_dpp v89, v17 quad_perm:[0,1,2,3] row_mask:0xf bank_mask:0x3
  v_mov_b32_dpp v90, v18 quad_perm:[0,1,2,3] row_mask:0xf bank_mask:0x3
  v_mov_b32_dpp v91, v19 quad_perm:[0,1,2,3] row_mask:0xf bank_mask:0x3
  v_mov_b32_dpp v16, v60 row_ror:8 row_mask:0xf bank_mask:0xf
  v_mov_b32_dpp v17, v61 row_ror:8 row_mask:0xf bank_mask:0xf
  v_mov_b32_dpp v18, v62 row_ror:8 row_mask:0xf bank_mask:0xf
  v_mov_b32_dpp v19, v63 row_ror:8 row_mask:0xf bank_mask:0xf
  v_mov_b32_dpp v60, v92 row_ror:8 row_mask:0xf bank_mask:0xc
  v_mov_b32_dpp v61, v93 row_ror:8 row_mask:0xf bank_mask:0xc
  v_mov_b32_dpp v62, v94 row_ror:8 row_mask:0xf bank_mask:0xc
  v_mov_b32_dpp v63, v95 row_ror:8 row_mask:0xf bank_mask:0xc
  v_mov_b32_dpp v92, v16 quad_perm:[0,1,2,3] row_mask:0xf bank_mask:0x3
  v_mov_b32_dpp v93, v17 quad_perm:[0,1,2,3] row_mask:0xf bank_mask:0x3
  v_mov_b32_dpp v94, v18 quad_perm:[0,1,2,3] row_mask:0xf bank_mask:0x3
  v_mov_b32_dpp v95, v19 quad_perm:[0,1,2,3] row_mask:0xf bank_mask:0x3
  s_lshl_b32 s24, s3, 14
  s_add_u32 s24, s24, 32768
  v_lshl_add_u32 v12, v1, 4, s24
  v_perm_b32 v16, v36, v32, s27
  v_perm_b32 v17, v44, v40, s27
  v_perm_b32 v18, v52, v48, s27
  v_perm_b32 v19, v60, v56, s27
  ds_write_b128 v12, v[16:19] offset:0
  v_perm_b32 v20, v36, v32, s28
  v_perm_b32 v21, v44, v40, s28
  v_perm_b32 v22, v52, v48, s28
  v_perm_b32 v23, v60, v56, s28
  ds_write_b128 v12, v[20:23] offset:1024
  v_perm_b32 v24, v37, v33, s27
  v_perm_b32 v25, v45, v41, s27
  v_perm_b32 v26, v53, v49, s27
  v_perm_b32 v27, v61, v57, s27
  ds_write_b128 v12, v[24:27] offset:2048
  v_perm_b32 v16, v37, v33, s28
  v_perm_b32 v17, v45, v41, s28
  v_perm_b32 v18, v53, v49, s28
  v_perm_b32 v19, v61, v57, s28
  ds_write_b128 v12, v[16:19] offset:3072
  v_perm_b32 v20, v38, v34, s27
  v_perm_b32 v21, v46, v42, s27
  v_perm_b32 v22, v54, v50, s27
  v_perm_b32 v23, v62, v58, s27
  ds_write_b128 v12, v[20:23] offset:4096
  v_perm_b32 v24, v38, v34, s28
  v_perm_b32 v25, v46, v42, s28
  v_perm_b32 v26, v54, v50, s28
  v_perm_b32 v27, v62, v58, s28
  ds_write_b128 v12, v[24:27] offset:5120
  v_perm_b32 v16, v39, v35, s27
  v_perm_b32 v17, v47, v43, s27
  v_perm_b32 v18, v55, v51, s27
  v_perm_b32 v19, v63, v59, s27
  ds_write_b128 v12, v[16:19] offset:6144
  v_perm_b32 v20, v39, v35, s28
  v_perm_b32 v21, v47, v43, s28
  v_perm_b32 v22, v55, v51, s28
  v_perm_b32 v23, v63, v59, s28
  ds_write_b128 v12, v[20:23] offset:7168
  v_perm_b32 v24, v68, v64, s27
  v_perm_b32 v25, v76, v72, s27
  v_perm_b32 v26, v84, v80, s27
  v_perm_b32 v27, v92, v88, s27
  ds_write_b128 v12, v[24:27] offset:8192
  v_perm_b32 v16, v68, v64, s28
  v_perm_b32 v17, v76, v72, s28
  v_perm_b32 v18, v84, v80, s28
  v_perm_b32 v19, v92, v88, s28
  ds_write_b128 v12, v[16:19] offset:9216
  v_perm_b32 v20, v69, v65, s27
  v_perm_b32 v21, v77, v73, s27
  v_perm_b32 v22, v85, v81, s27
  v_perm_b32 v23, v93, v89, s27
  ds_write_b128 v12, v[20:23] offset:10240
  v_perm_b32 v24, v69, v65, s28
  v_perm_b32 v25, v77, v73, s28
  v_perm_b32 v26, v85, v81, s28
  v_perm_b32 v27, v93, v89, s28
  ds_write_b128 v12, v[24:27] offset:11264
  v_perm_b32 v16, v70, v66, s27
  v_perm_b32 v17, v78, v74, s27
  v_perm_b32 v18, v86, v82, s27
  v_perm_b32 v19, v94, v90, s27
  ds_write_b128 v12, v[16:19] offset:12288
  v_perm_b32 v20, v70, v66, s28
  v_perm_b32 v21, v78, v74, s28
  v_perm_b32 v22, v86, v82, s28
  v_perm_b32 v23, v94, v90, s28
  ds_write_b128 v12, v[20:23] offset:13312
  v_perm_b32 v24, v71, v67, s27
  v_perm_b32 v25, v79, v75, s27
  v_perm_b32 v26, v87, v83, s27
  v_perm_b32 v27, v95, v91, s27
  ds_write_b128 v12, v[24:27] offset:14336
  v_perm_b32 v16, v71, v67, s28
  v_perm_b32 v17, v79, v75, s28
  v_perm_b32 v18, v87, v83, s28
  v_perm_b32 v19, v95, v91, s28
  ds_write_b128 v12, v[16:19] offset:15360
  v_mov_b32 v29, 0
  s_mov_b32 s31, 0
  s_branch L_pfc44
L_pf42:
  buffer_load_dword v30, v29, s[16:19], 0 offen sc1
  s_waitcnt vmcnt(0)
L_pfc44:
  v_cmp_gt_u32 vcc, 0x40000000, v30
  s_cbranch_vccz L_pfd43
  s_add_u32 s31, s31, 1
  s_cmp_ge_u32 s31, 131072
  s_cbranch_scc1 L_pfd43
  s_sleep 4
  s_branch L_pf42
L_pfd43:
  v_readfirstlane_b32 s24, v30
  s_lshl_b32 s10, s10, 5
  s_cmp_eq_u32 s24, s10
  s_cselect_b32 s101, 1, 0
  v_and_b32 v29, 3, v1
  v_bfe_u32 v28, v1, 3, 1
  v_lshrrev_b32 v6, 1, v3
  v_lshl_add_u32 v6, v28, 1, v6
  v_and_b32 v28, 1, v3
  v_bfe_u32 v30, v1, 2, 1
  v_lshl_add_u32 v30, v28, 1, v30
  v_lshlrev_b32 v28, 10, v29
  v_lshl_add_u32 v28, v6, 5, v28
  v_lshl_add_u32 v28, v30, 1, v28
  s_add_u32 s92, s29, 36864
  s_add_u32 s93, s92, 4096
  s_add_u32 s94, s26, 32768
  s_add_u32 s95, s26, 45056
  buffer_load_ushort v250, v7, s[64:67], s26 offen
  s_cmp_lg_u32 s101, 1
  s_cbranch_scc1 L_pt45
  v_lshlrev_b32 v12, 4, v0
  v_min_u32 v14, 0x1bf0, v12
  s_add_u32 s68, s21, 24576
  s_add_u32 s69, s21, 32768
  s_mov_b32 s70, 49152
  s_mov_b32 s71, 57344
  buffer_load_dwordx4 v[32:35], v12, s[12:15], s68 offen sc1
  buffer_load_dwordx4 v[36:39], v14, s[12:15], s69 offen sc1
  buffer_load_dwordx4 v[40:43], v12, s[12:15], s70 offen sc1
  buffer_load_dwordx4 v[44:47], v12, s[12:15], s71 offen sc1
L_pt45:
  s_mov_b32 s31, 0
L_pd46:
  buffer_load_ushort v240, v28, s[12:15], s92 offen offset:0 sc1
  buffer_load_ushort v241, v28, s[12:15], s92 offen offset:8 sc1
  buffer_load_ushort v242, v28, s[12:15], s92 offen offset:16 sc1
  buffer_load_ushort v243, v28, s[12:15], s92 offen offset:24 sc1
  buffer_load_ushort v236, v28, s[12:15], s93 offen offset:0 sc1
  buffer_load_ushort v237, v28, s[12:15], s93 offen offset:8 sc1
  buffer_load_ushort v238, v28, s[12:15], s93 offen offset:16 sc1
  buffer_load_ushort v239, v28, s[12:15], s93 offen offset:24 sc1
  buffer_load_ushort v102, v7, s[12:15], s94 offen sc1
  buffer_load_ushort v103, v7, s[12:15], s95 offen sc1
  s_waitcnt vmcnt(0)
  v_max3_u32 v13, v236, v237, v238
  v_max3_u32 v13, v13, v239, v240
  v_max3_u32 v13, v13, v241, v242
  v_max3_u32 v13, v13, v243, v102
  v_max_u32 v13, v13, v103
  v_cmp_eq_u32 vcc, 0xffff, v13
  s_cbranch_vccz L_pdd47
  s_add_u32 s31, s31, 1
  s_cmp_ge_u32 s31, 131072
  s_cbranch_scc1 L_pdd47
  s_sleep 8
  s_branch L_pd46
L_pdd47:
  s_mov_b32 s20, s2
  s_mov_b32 s21, 7
  s_lshr_b32 s25, s20, 3
  s_and_b32 s26, s20, 7
  s_lshl_b32 s24, s20, 21
  v_lshlrev_b32 v3, 4, v1
  v_and_b32 v2, 12, v1
  v_lshlrev_b32 v2, 6, v2
  v_and_b32 v4, 48, v1
  v_lshl_add_u32 v2, v4, 2, v2
  v_and_b32 v4, 3, v1
  v_lshl_add_u32 v2, v4, 4, v2
  s_add_u32 s4, s38, s24
  s_addc_u32 s5, s39, 0
  s_mov_b32 s6, 0x200000
  s_mov_b32 s7, 0x20000
  s_add_u32 s8, s40, s24
  s_addc_u32 s9, s41, 0
  s_mov_b32 s10, 0x200000
  s_mov_b32 s11, 0x20000
  s_mov_b32 s29, 0x3db504f3
  v_lshlrev_b32 v6, 8, v4
  v_lshrrev_b32 v7, 2, v1
  v_lshl_add_u32 v6, v7, 4, v6
  v_lshrrev_b32 v5, 5, v1
  v_mul_u32_u24 v5, 136, v5
  s_lshl_b32 s65, s25, 13
  s_lshl_b32 s66, s26, 10
  s_add_u32 s65, s65, s66
  s_add_u32 s65, s65, 65536
  s_mul_i32 s64, s20, 40960
  s_add_u32 s64, s64, 171520
  s_cmp_eq_u32 s21, 7
  s_cselect_b32 s91, 1769472, -1
  v_mov_b32 v253, 1
  s_mov_b64 exec, 1
  buffer_atomic_add v253, off, s[12:15], s64 sc0 sc1
  s_mov_b64 exec, -1
  buffer_load_dwordx4 v[232:235], v6, s[12:15], s65 offen sc1
  v_mov_b32_dpp v16, v200 row_ror:8 row_mask:0xf bank_mask:0xf
  v_mov_b32_dpp v17, v201 row_ror:8 row_mask:0xf bank_mask:0xf
  v_mov_b32_dpp v18, v204 row_ror:8 row_mask:0xf bank_mask:0xf
  v_mov_b32_dpp v19, v205 row_ror:8 row_mask:0xf bank_mask:0xf
  v_mov_b32_dpp v200, v202 row_ror:8 row_mask:0xf bank_mask:0xc
  v_mov_b32_dpp v201, v203 row_ror:8 row_mask:0xf bank_mask:0xc
  v_mov_b32_dpp v204, v206 row_ror:8 row_mask:0xf bank_mask:0xc
  v_mov_b32_dpp v205, v207 row_ror:8 row_mask:0xf bank_mask:0xc
  v_mov_b32_dpp v202, v16 quad_perm:[0,1,2,3] row_mask:0xf bank_mask:0x3
  v_mov_b32_dpp v203, v17 quad_perm:[0,1,2,3] row_mask:0xf bank_mask:0x3
  v_mov_b32_dpp v206, v18 quad_perm:[0,1,2,3] row_mask:0xf bank_mask:0x3
  v_mov_b32_dpp v207, v19 quad_perm:[0,1,2,3] row_mask:0xf bank_mask:0x3
  v_mov_b32_dpp v16, v208 row_ror:8 row_mask:0xf bank_mask:0xf
  v_mov_b32_dpp v17, v209 row_ror:8 row_mask:0xf bank_mask:0xf
  v_mov_b32_dpp v18, v212 row_ror:8 row_mask:0xf bank_mask:0xf
  v_mov_b32_dpp v19, v213 row_ror:8 row_mask:0xf bank_mask:0xf
  v_mov_b32_dpp v208, v210 row_ror:8 row_mask:0xf bank_mask:0xc
  v_mov_b32_dpp v209, v211 row_ror:8 row_mask:0xf bank_mask:0xc
  v_mov_b32_dpp v212, v214 row_ror:8 row_mask:0xf bank_mask:0xc
  v_mov_b32_dpp v213, v215 row_ror:8 row_mask:0xf bank_mask:0xc
  v_mov_b32_dpp v210, v16 quad_perm:[0,1,2,3] row_mask:0xf bank_mask:0x3
  v_mov_b32_dpp v211, v17 quad_perm:[0,1,2,3] row_mask:0xf bank_mask:0x3
  v_mov_b32_dpp v214, v18 quad_perm:[0,1,2,3] row_mask:0xf bank_mask:0x3
  v_mov_b32_dpp v215, v19 quad_perm:[0,1,2,3] row_mask:0xf bank_mask:0x3
  v_mov_b32_dpp v16, v216 row_ror:8 row_mask:0xf bank_mask:0xf
  v_mov_b32_dpp v17, v217 row_ror:8 row_mask:0xf bank_mask:0xf
  v_mov_b32_dpp v18, v220 row_ror:8 row_mask:0xf bank_mask:0xf
  v_mov_b32_dpp v19, v221 row_ror:8 row_mask:0xf bank_mask:0xf
  v_mov_b32_dpp v216, v218 row_ror:8 row_mask:0xf bank_mask:0xc
  v_mov_b32_dpp v217, v219 row_ror:8 row_mask:0xf bank_mask:0xc
  v_mov_b32_dpp v220, v222 row_ror:8 row_mask:0xf bank_mask:0xc
  v_mov_b32_dpp v221, v223 row_ror:8 row_mask:0xf bank_mask:0xc
  v_mov_b32_dpp v218, v16 quad_perm:[0,1,2,3] row_mask:0xf bank_mask:0x3
  v_mov_b32_dpp v219, v17 quad_perm:[0,1,2,3] row_mask:0xf bank_mask:0x3
  v_mov_b32_dpp v222, v18 quad_perm:[0,1,2,3] row_mask:0xf bank_mask:0x3
  v_mov_b32_dpp v223, v19 quad_perm:[0,1,2,3] row_mask:0xf bank_mask:0x3
  v_mov_b32_dpp v16, v224 row_ror:8 row_mask:0xf bank_mask:0xf
  v_mov_b32_dpp v17, v225 row_ror:8 row_mask:0xf bank_mask:0xf
  v_mov_b32_dpp v18, v228 row_ror:8 row_mask:0xf bank_mask:0xf
  v_mov_b32_dpp v19, v229 row_ror:8 row_mask:0xf bank_mask:0xf
  v_mov_b32_dpp v224, v226 row_ror:8 row_mask:0xf bank_mask:0xc
  v_mov_b32_dpp v225, v227 row_ror:8 row_mask:0xf bank_mask:0xc
  v_mov_b32_dpp v228, v230 row_ror:8 row_mask:0xf bank_mask:0xc
  v_mov_b32_dpp v229, v231 row_ror:8 row_mask:0xf bank_mask:0xc
  v_mov_b32_dpp v226, v16 quad_perm:[0,1,2,3] row_mask:0xf bank_mask:0x3
  v_mov_b32_dpp v227, v17 quad_perm:[0,1,2,3] row_mask:0xf bank_mask:0x3
  v_mov_b32_dpp v230, v18 quad_perm:[0,1,2,3] row_mask:0xf bank_mask:0x3
  v_mov_b32_dpp v231, v19 quad_perm:[0,1,2,3] row_mask:0xf bank_mask:0x3
  v_perm_b32 v168, v204, v200, s27
  v_perm_b32 v169, v212, v208, s27
  v_perm_b32 v170, v220, v216, s27
  v_perm_b32 v171, v228, v224, s27
  v_perm_b32 v172, v204, v200, s28
  v_perm_b32 v173, v212, v208, s28
  v_perm_b32 v174, v220, v216, s28
  v_perm_b32 v175, v228, v224, s28
  v_perm_b32 v176, v205, v201, s27
  v_perm_b32 v177, v213, v209, s27
  v_perm_b32 v178, v221, v217, s27
  v_perm_b32 v179, v229, v225, s27
  v_perm_b32 v180, v205, v201, s28
  v_perm_b32 v181, v213, v209, s28
  v_perm_b32 v182, v221, v217, s28
  v_perm_b32 v183, v229, v225, s28
  v_perm_b32 v184, v206, v202, s27
  v_perm_b32 v185, v214, v210, s27
  v_perm_b32 v186, v222, v218, s27
  v_perm_b32 v187, v230, v226, s27
  v_perm_b32 v188, v206, v202, s28
  v_perm_b32 v189, v214, v210, s28
  v_perm_b32 v190, v222, v218, s28
  v_perm_b32 v191, v230, v226, s28
  v_perm_b32 v192, v207, v203, s27
  v_perm_b32 v193, v215, v211, s27
  v_perm_b32 v194, v223, v219, s27
  v_perm_b32 v195, v231, v227, s27
  v_perm_b32 v196, v207, v203, s28
  v_perm_b32 v197, v215, v211, s28
  v_perm_b32 v198, v223, v219, s28
  v_perm_b32 v199, v231, v227, s28
  v_lshlrev_b32 v240, 16, v240
  v_lshlrev_b32 v241, 16, v241
  v_lshlrev_b32 v242, 16, v242
  v_lshlrev_b32 v243, 16, v243
  v_lshlrev_b32 v236, 16, v236
  v_lshlrev_b32 v237, 16, v237
  v_lshlrev_b32 v238, 16, v238
  v_lshlrev_b32 v239, 16, v239
  v_lshlrev_b32 v102, 16, v102
  v_lshlrev_b32 v103, 16, v103
  v_lshlrev_b32 v250, 16, v250
  v_add_f32 v236, 1.0, v236
  v_add_f32 v237, 1.0, v237
  v_add_f32 v238, 1.0, v238
  v_add_f32 v239, 1.0, v239
  v_cvt_pk_bf16_f32 v13, v236, v237
  v_lshlrev_b32 v236, 16, v13
  v_and_b32 v237, 0xffff0000, v13
  v_cvt_pk_bf16_f32 v13, v238, v239
  v_lshlrev_b32 v238, 16, v13
  v_and_b32 v239, 0xffff0000, v13
  s_waitcnt lgkmcnt(0)
  v_mov_b32 v8, 0
  v_mov_b32 v9, 0
  v_mov_b32 v10, 0
  v_mov_b32 v11, 0
  v_mov_b32 v12, 0
  v_mov_b32 v13, 0
  v_mov_b32 v14, 0
  v_mov_b32 v15, 0
  v_mov_b32 v16, 0
  v_mov_b32 v17, 0
  v_mov_b32 v18, 0
  v_mov_b32 v19, 0
  v_mov_b32 v20, 0
  v_mov_b32 v21, 0
  v_mov_b32 v22, 0
  v_mov_b32 v23, 0
  v_mov_b32 v24, 0
  v_mov_b32 v25, 0
  v_mov_b32 v26, 0
  v_mov_b32 v27, 0
  v_mov_b32 v28, 0
  v_mov_b32 v29, 0
  v_mov_b32 v30, 0
  v_mov_b32 v31, 0
  s_mov_b32 s32, 0x000f000f
  s_mov_b32 s33, 0x000f000f
  v_mov_b32 v18, 0
  v_mov_b32 v22, 0
  v_mov_b32 v26, 0
  v_mov_b32 v30, 0
  v_mov_b32 v42, 0
  v_mov_b32 v46, 0
  v_mov_b32 v50, 0
  v_mov_b32 v54, 0
  v_mov_b32 v58, 0
  v_mov_b32 v62, 0
  v_mov_b32 v66, 0
  v_mov_b32 v70, 0
  v_mov_b32 v19, 0
  v_mov_b32 v23, 0
  v_mov_b32 v27, 0
  v_mov_b32 v31, 0
  v_mov_b32 v43, 0
  v_mov_b32 v47, 0
  v_mov_b32 v51, 0
  v_mov_b32 v55, 0
  v_mov_b32 v59, 0
  v_mov_b32 v63, 0
  v_mov_b32 v67, 0
  v_mov_b32 v71, 0
  s_mul_i32 s24, s3, 2112
  v_mul_u32_u24 v93, 528, v4
  v_and_b32 v94, 48, v1
  v_add3_u32 v93, v93, v94, s24
  v_and_b32 v94, 12, v1
  v_lshl_add_u32 v93, v94, 4, v93
  s_lshl_b32 s24, s3, 5
  s_add_u32 s24, s24, 16896
  v_lshl_add_u32 v96, v4, 3, s24
  s_lshr_b32 s66, s3, 1
  s_lshl_b32 s24, s66, 3
  s_add_u32 s24, s24, 16896
  v_and_b32 v97, 7, v1
  v_lshl_add_u32 v97, v97, 5, s24
  s_lshl_b32 s67, s26, 2
  s_add_u32 s67, s67, s66
  s_mul_i32 s67, s67, 40960
  s_add_u32 s67, s67, 131072
  s_mul_i32 s24, s66, 528
  s_and_b32 s76, s3, 1
  s_lshl_b32 s76, s76, 8
  s_add_u32 s24, s24, s76
  v_lshl_add_u32 v94, v1, 2, s24
  v_lshlrev_b32 v95, 2, v1
  s_lshl_b32 s24, s25, 3
  s_add_u32 s24, s24, s21
  s_lshl_b32 s24, s24, 9
  s_add_u32 s24, s24, s76
  s_add_u32 s80, s24, s67
  s_lshr_b32 s24, s24, 1
  s_add_u32 s79, s24, s67
  s_add_u32 s79, s79, 16384
  v_mov_b32 v100, 0
  v_mov_b32 v101, 1
  v_mov_b32 v88, 0xff7fffff
  v_mov_b32 v89, 0
  s_mov_b32 s77, 0
  s_waitcnt vmcnt(0)
  v_readfirstlane_b32 s22, v253
  s_nop 0
  s_add_u32 s22, s22, 9
  s_cmp_ge_u32 s22, 176
  s_cbranch_scc1 L_att_none
  s_mul_i32 s22, s22, 4096
  s_add_u32 s22, s22, 1376256
  s_waitcnt vmcnt(6)
  buffer_load_dwordx4 v[200:203], v2, s[4:7], s22 offen offset:0 nt
  s_waitcnt vmcnt(6)
  buffer_load_dwordx4 v[204:207], v2, s[4:7], s22 offen offset:1024 nt
  s_waitcnt vmcnt(6)
  buffer_load_dwordx4 v[208:211], v2, s[4:7], s22 offen offset:2048 nt
  s_waitcnt vmcnt(6)
  buffer_load_dwordx4 v[212:215], v2, s[4:7], s22 offen offset:3072 nt
  v_mov_b32 v253, 1
  s_mov_b64 exec, 1
  buffer_atomic_add v253, off, s[12:15], s64 sc0 sc1
  s_mov_b64 exec, -1
  s_waitcnt vmcnt(6)
  buffer_load_dwordx4 v[216:219], v3, s[8:11], s22 offen offset:0 nt
  s_waitcnt vmcnt(6)
  buffer_load_dwordx4 v[220:223], v3, s[8:11], s22 offen offset:1024 nt
  s_waitcnt vmcnt(6)
  buffer_load_dwordx4 v[224:227], v3, s[8:11], s22 offen offset:2048 nt
  s_waitcnt vmcnt(6)
  buffer_load_dwordx4 v[228:231], v3, s[8:11], s22 offen offset:3072 nt
  v_max3_u32 v252, v232, v233, v234
  v_max_u32 v252, v252, v235
  v_cmp_eq_u32 vcc, -1, v252
  s_cbranch_vccz L_att_loop
  s_mov_b32 s31, 0
L_pd48:
  buffer_load_dwordx4 v[232:235], v6, s[12:15], s65 offen sc1
  s_waitcnt vmcnt(0)
  v_max3_u32 v252, v232, v233, v234
  v_max_u32 v252, v252, v235
  v_cmp_eq_u32 vcc, -1, v252
  s_cbranch_vccz L_pdd49
  s_add_u32 s31, s31, 1
  s_cmp_ge_u32 s31, 131072
  s_cbranch_scc1 L_pdd49
  s_sleep 2
  s_branch L_pd48
L_pdd49:
  s_branch L_att_loop
L_epilogue:
  s_sub_u32 s20, 31, s2
  s_mul_i32 s21, s20, 40960
  s_add_u32 s21, s21, 131072
  s_lshr_b32 s25, s3, 1
  s_and_b32 s23, s3, 1
  v_lshlrev_b32 v97, 2, v1
  v_and_b32 v13, 7, v1
  v_lshlrev_b32 v13, 8, v13
  s_lshl_b32 s72, s25, 12
  s_lshl_b32 s24, s23, 8
  s_add_u32 s72, s72, s24
  s_lshr_b32 s71, s72, 1
  s_add_u32 s71, s71, s21
  s_add_u32 s71, s71, 16384
  s_add_u32 s72, s72, s21
  buffer_load_dwordx2 v[24:25], v13, s[12:15], s71 offen sc1
  buffer_load_dword v16, v97, s[12:15], s72 offen offset:0 sc1
  buffer_load_dword v17, v97, s[12:15], s72 offen offset:512 sc1
  buffer_load_dword v18, v97, s[12:15], s72 offen offset:1024 sc1
  buffer_load_dword v19, v97, s[12:15], s72 offen offset:1536 sc1
  buffer_load_dword v20, v97, s[12:15], s72 offen offset:2048 sc1
  buffer_load_dword v21, v97, s[12:15], s72 offen offset:2560 sc1
  buffer_load_dword v22, v97, s[12:15], s72 offen offset:3072 sc1
  buffer_load_dword v23, v97, s[12:15], s72 offen offset:3584 sc1
  s_lshl_b32 s24, s3, 14
  s_add_u32 s24, s24, 32768
  v_lshl_add_u32 v12, v1, 4, s24
  ds_read_b128 v[64:67], v12 offset:0
  ds_read_b128 v[68:71], v12 offset:1024
  ds_read_b128 v[72:75], v12 offset:2048
  ds_read_b128 v[76:79], v12 offset:3072
  ds_read_b128 v[80:83], v12 offset:4096
  ds_read_b128 v[84:87], v12 offset:5120
  ds_read_b128 v[88:91], v12 offset:6144
  ds_read_b128 v[92:95], v12 offset:7168
  ds_read_b128 v[200:203], v12 offset:8192
  ds_read_b128 v[204:207], v12 offset:9216
  ds_read_b128 v[208:211], v12 offset:10240
  ds_read_b128 v[212:215], v12 offset:11264
  ds_read_b128 v[216:219], v12 offset:12288
  ds_read_b128 v[220:223], v12 offset:13312
  ds_read_b128 v[224:227], v12 offset:14336
  ds_read_b128 v[228:231], v12 offset:15360
  v_and_b32 v2, 15, v1
  v_lshrrev_b32 v3, 4, v1
  s_lshl_b32 s26, s20, 5
  s_mov_b32 s11, s101
  v_and_b32 v7, 3, v2
  v_lshlrev_b32 v7, 3, v7
  v_lshrrev_b32 v28, 2, v2
  v_lshl_add_u32 v7, v28, 1, v7
  v_lshl_add_u32 v7, v3, 10, v7
  s_mov_b32 s88, s58
  s_mov_b32 s89, s59
  s_mov_b32 s90, 0x1000
  s_mov_b32 s91, 0x20000
  v_lshlrev_b32 v10, 2, v0
  v_and_b32 v29, 3, v1
  v_bfe_u32 v28, v1, 3, 1
  v_lshrrev_b32 v6, 1, v3
  v_lshl_add_u32 v6, v28, 1, v6
  v_and_b32 v28, 1, v3
  v_bfe_u32 v30, v1, 2, 1
  v_lshl_add_u32 v30, v28, 1, v30
  v_lshlrev_b32 v4, 8, v6
  v_lshl_add_u32 v4, v29, 6, v4
  v_lshl_add_u32 v4, v30, 4, v4
  s_lshl_b32 s22, s3, 10
  s_add_u32 s22, s22, 49152
  s_lshl_b32 s70, s20, 8
  s_add_u32 s70, s70, 49152
  v_lshlrev_b32 v100, 4, v3
  s_lshr_b32 s73, s20, 1
  s_lshl_b32 s73, s73, 6
  s_and_b32 s24, s20, 1
  s_lshl_b32 s24, s24, 3
  s_add_u32 s73, s73, s24
  s_add_u32 s73, s73, 57344
  s_mov_b32 s76, 57344
  s_mov_b32 s74, 0x00010001
  s_mov_b32 s75, 0x00010001
  v_mul_u32_u24 v96, 160, v29
  v_mul_u32_u24 v30, 288, v29
  v_bfe_u32 v233, v1, 2, 3
  v_lshl_add_u32 v232, v233, 4, v96
  s_lshl_b32 s24, s3, 1
  s_add_u32 s24, s24, 21952
  v_add_u32 v232, s24, v232
  v_lshl_add_u32 v30, v3, 4, v30
  v_lshl_add_u32 v96, v3, 4, v96
  s_mul_i32 s24, s25, 288
  s_lshl_b32 s94, s23, 7
  s_add_u32 s24, s24, s94
  s_add_u32 s24, s24, 20800
  v_lshl_add_u32 v29, v1, 1, s24
  v_bfe_u32 v98, v2, 1, 2
  s_lshl_b32 s24, s3, 2
  v_add_u32 v98, s24, v98
  v_mul_u32_u24 v98, 40960, v98
  v_and_b32 v233, 1, v2
  v_lshl_add_u32 v98, v233, 5, v98
  v_and_b32 v233, 8, v2
  v_lshl_add_u32 v98, v233, 1, v98
  v_lshl_add_u32 v98, v3, 6, v98
  s_lshl_b32 s24, s20, 8
  s_add_u32 s8, s24, 155648
  s_add_u32 s9, s24, 163840
  s_lshl_b32 s24, s3, 10
  s_add_u32 s24, s24, s21
  s_add_u32 s68, s24, 24576
  s_add_u32 s69, s24, 32768
  v_lshlrev_b32 v99, 4, v1
  s_lshl_b32 s24, s3, 11
  s_add_u32 s24, s24, 4352
  v_add_u32 v101, s24, v99
  s_waitcnt vmcnt(0)
  v_max_u32 v233, v24, v25
  v_cmp_eq_u32 vcc, -1, v233
  s_cbranch_vccz L_mok50
  s_mov_b32 s31, 0
L_pd51:
  buffer_load_dwordx2 v[24:25], v13, s[12:15], s71 offen sc1
  buffer_load_dword v16, v97, s[12:15], s72 offen offset:0 sc1
  buffer_load_dword v17, v97, s[12:15], s72 offen offset:512 sc1
  buffer_load_dword v18, v97, s[12:15], s72 offen offset:1024 sc1
  buffer_load_dword v19, v97, s[12:15], s72 offen offset:1536 sc1
  buffer_load_dword v20, v97, s[12:15], s72 offen offset:2048 sc1
  buffer_load_dword v21, v97, s[12:15], s72 offen offset:2560 sc1
  buffer_load_dword v22, v97, s[12:15], s72 offen offset:3072 sc1
  buffer_load_dword v23, v97, s[12:15], s72 offen offset:3584 sc1
  s_waitcnt vmcnt(0)
  v_max_u32 v233, v24, v25
  v_cmp_eq_u32 vcc, -1, v233
  s_cbranch_vccz L_pdd52
  s_add_u32 s31, s31, 1
  s_cmp_ge_u32 s31, 131072
  s_cbranch_scc1 L_pdd52
  s_sleep 2
  s_branch L_pd51
L_pdd52:
L_mok50:
  v_max_f32_dpp v26, v24, v24 quad_perm:[1,0,3,2] row_mask:0xf bank_mask:0xf
  s_nop 1
  v_max_f32_dpp v26, v26, v26 quad_perm:[2,3,0,1] row_mask:0xf bank_mask:0xf
  s_nop 1
  v_max_f32_dpp v26, v26, v26 row_half_mirror row_mask:0xf bank_mask:0xf
  v_sub_f32 v27, v24, v26
  v_exp_f32 v27, v27
  s_nop 0
  v_mul_f32 v14, v27, v25
  s_nop 1
  v_add_f32_dpp v14, v14, v14 quad_perm:[1,0,3,2] row_mask:0xf bank_mask:0xf
  s_nop 1
  v_add_f32_dpp v14, v14, v14 quad_perm:[2,3,0,1] row_mask:0xf bank_mask:0xf
  s_nop 1
  v_add_f32_dpp v14, v14, v14 row_half_mirror row_mask:0xf bank_mask:0xf
  v_rcp_f32 v14, v14
  s_nop 0
  v_mul_f32 v27, v27, v14
  s_nop 0
  v_readlane_b32 s92, v27, 0
  v_readlane_b32 s93, v27, 1
  v_readlane_b32 s94, v27, 2
  v_readlane_b32 s95, v27, 3
  v_readlane_b32 s96, v27, 4
  v_readlane_b32 s97, v27, 5
  v_readlane_b32 s98, v27, 6
  v_readlane_b32 s99, v27, 7
  v_max3_u32 v233, v16, v17, v18
  v_max3_u32 v233, v233, v19, v20
  v_max3_u32 v233, v233, v21, v22
  v_max_u32 v233, v233, v23
  v_cmp_eq_u32 vcc, -1, v233
  s_cbranch_vccz L_ook53
  s_mov_b32 s31, 0
L_pd54:
  buffer_load_dword v16, v97, s[12:15], s72 offen offset:0 sc1
  buffer_load_dword v17, v97, s[12:15], s72 offen offset:512 sc1
  buffer_load_dword v18, v97, s[12:15], s72 offen offset:1024 sc1
  buffer_load_dword v19, v97, s[12:15], s72 offen offset:1536 sc1
  buffer_load_dword v20, v97, s[12:15], s72 offen offset:2048 sc1
  buffer_load_dword v21, v97, s[12:15], s72 offen offset:2560 sc1
  buffer_load_dword v22, v97, s[12:15], s72 offen offset:3072 sc1
  buffer_load_dword v23, v97, s[12:15], s72 offen offset:3584 sc1
  s_waitcnt vmcnt(0)
  v_max3_u32 v233, v16, v17, v18
  v_max3_u32 v233, v233, v19, v20
  v_max3_u32 v233, v233, v21, v22
  v_max_u32 v233, v233, v23
  v_cmp_eq_u32 vcc, -1, v233
  s_cbranch_vccz L_pdd55
  s_add_u32 s31, s31, 1
  s_cmp_ge_u32 s31, 131072
  s_cbranch_scc1 L_pdd55
  s_branch L_pd54
L_pdd55:
L_ook53:
  v_mul_f32 v16, s92, v16
  v_mul_f32 v17, s93, v17
  v_fmac_f32 v16, s94, v18
  v_fmac_f32 v17, s95, v19
  v_fmac_f32 v16, s96, v20
  v_fmac_f32 v17, s97, v21
  v_fmac_f32 v16, s98, v22
  v_fmac_f32 v17, s99, v23
  v_add_f32 v16, v16, v17
  v_cvt_pk_bf16_f32 v16, v16, v16
  ds_write_b16 v29, v16
  s_waitcnt lgkmcnt(0)
  s_barrier
  ds_read_b128 v[48:51], v30 offset:20800
  ds_read_b128 v[52:55], v30 offset:20864
  ds_read_b128 v[56:59], v30 offset:20928
  ds_read_b128 v[60:63], v30 offset:20992
  s_waitcnt lgkmcnt(3)
  v_mfma_f32_16x16x32_bf16 v[32:35], v[48:51], v[104:107], 0
  v_mfma_f32_16x16x32_bf16 v[36:39], v[48:51], v[108:111], 0
  s_waitcnt lgkmcnt(2)
  v_mfma_f32_16x16x32_bf16 v[32:35], v[52:55], v[120:123], v[32:35]
  v_mfma_f32_16x16x32_bf16 v[36:39], v[52:55], v[124:127], v[36:39]
  s_waitcnt lgkmcnt(1)
  v_mfma_f32_16x16x32_bf16 v[32:35], v[56:59], v[136:139], v[32:35]
  v_mfma_f32_16x16x32_bf16 v[36:39], v[56:59], v[140:143], v[36:39]
  s_waitcnt lgkmcnt(0)
  v_mfma_f32_16x16x32_bf16 v[32:35], v[60:63], v[152:155], v[32:35]
  v_mfma_f32_16x16x32_bf16 v[36:39], v[60:63], v[156:159], v[36:39]
  v_mfma_f32_16x16x32_bf16 v[40:43], v[48:51], v[112:115], 0
  v_mfma_f32_16x16x32_bf16 v[40:43], v[52:55], v[128:131], v[40:43]
  v_mfma_f32_16x16x32_bf16 v[40:43], v[56:59], v[144:147], v[40:43]
  v_mfma_f32_16x16x32_bf16 v[40:43], v[60:63], v[160:163], v[40:43]
  v_mfma_f32_16x16x32_bf16 v[44:47], v[48:51], v[116:119], 0
  v_mfma_f32_16x16x32_bf16 v[44:47], v[52:55], v[132:135], v[44:47]
  v_mfma_f32_16x16x32_bf16 v[44:47], v[56:59], v[148:151], v[44:47]
  v_mfma_f32_16x16x32_bf16 v[44:47], v[60:63], v[164:167], v[44:47]
  s_cmp_eq_u32 s11, 1
  v_mov_b32_dpp v32, v36 quad_perm:[0,1,2,3] row_mask:0x2 bank_mask:0xf
  v_mov_b32_dpp v33, v37 quad_perm:[0,1,2,3] row_mask:0x2 bank_mask:0xf
  v_mov_b32_dpp v34, v38 quad_perm:[0,1,2,3] row_mask:0x2 bank_mask:0xf
  v_mov_b32_dpp v35, v39 quad_perm:[0,1,2,3] row_mask:0x2 bank_mask:0xf
  v_mov_b32_dpp v32, v40 quad_perm:[0,1,2,3] row_mask:0x4 bank_mask:0xf
  v_mov_b32_dpp v33, v41 quad_perm:[0,1,2,3] row_mask:0x4 bank_mask:0xf
  v_mov_b32_dpp v34, v42 quad_perm:[0,1,2,3] row_mask:0x4 bank_mask:0xf
  v_mov_b32_dpp v35, v43 quad_perm:[0,1,2,3] row_mask:0x4 bank_mask:0xf
  v_mov_b32_dpp v32, v44 quad_perm:[0,1,2,3] row_mask:0x8 bank_mask:0xf
  v_mov_b32_dpp v33, v45 quad_perm:[0,1,2,3] row_mask:0x8 bank_mask:0xf
  v_mov_b32_dpp v34, v46 quad_perm:[0,1,2,3] row_mask:0x8 bank_mask:0xf
  v_mov_b32_dpp v35, v47 quad_perm:[0,1,2,3] row_mask:0x8 bank_mask:0xf
  s_cbranch_scc1 L_sf56
  buffer_store_dwordx4 v[32:35], v98, s[12:15], s8 offen sc1
  s_sleep 8
  s_branch L_sd57
L_sf56:
  buffer_store_dwordx4 v[32:35], v98, s[12:15], s8 offen
L_sd57:
  v_mov_b32 v136, 0
  v_mov_b32 v137, 0
  v_mov_b32 v138, 0
  v_mov_b32 v139, 0
  v_mov_b32 v140, 0
  v_mov_b32 v141, 0
  v_mov_b32 v142, 0
  v_mov_b32 v143, 0
  v_mov_b32 v144, 0
  v_mov_b32 v145, 0
  v_mov_b32 v146, 0
  v_mov_b32 v147, 0
  v_mov_b32 v148, 0
  v_mov_b32 v149, 0
  v_mov_b32 v150, 0
  v_mov_b32 v151, 0
  v_mov_b32 v152, 0
  v_mov_b32 v153, 0
  v_mov_b32 v154, 0
  v_mov_b32 v155, 0
  v_mov_b32 v156, 0
  v_mov_b32 v157, 0
  v_mov_b32 v158, 0
  v_mov_b32 v159, 0
  v_mov_b32 v160, 0
  v_mov_b32 v161, 0
  v_mov_b32 v162, 0
  v_mov_b32 v163, 0
  v_mov_b32 v164, 0
  v_mov_b32 v165, 0
  v_mov_b32 v166, 0
  v_mov_b32 v167, 0
  s_mov_b32 s31, 0
L_pd60:
  buffer_load_dwordx4 v[36:39], v99, s[12:15], s68 offen sc1
  s_waitcnt vmcnt(0)
  v_max3_u32 v16, v36, v37, v38
  v_max_u32 v16, v16, v39
  v_cmp_eq_u32 vcc, -1, v16
  s_cbranch_vccz L_pdd61
  s_add_u32 s31, s31, 1
  s_cmp_ge_u32 s31, 131072
  s_cbranch_scc1 L_pdd61
  s_branch L_pd60
L_pdd61:
  v_permlane32_swap_b32 v36, v38
  v_permlane32_swap_b32 v37, v39
  v_add_f32 v36, v36, v38
  v_add_f32 v37, v37, v39
  s_nop 1
  v_permlane16_swap_b32 v36, v37
  v_add_f32 v36, v36, v37
  ds_write_b32 v10, v36 offset:23040
L_sp59:
  s_waitcnt lgkmcnt(0)
  s_barrier
  s_cmp_lg_u32 s3, 0
  s_cbranch_scc1 L_idle62
  ds_read2st64_b32 v[36:37], v97 offset0:90 offset1:91
  ds_read2st64_b32 v[38:39], v97 offset0:92 offset1:93
  ds_read2st64_b32 v[40:41], v97 offset0:94 offset1:95
  ds_read2st64_b32 v[42:43], v97 offset0:96 offset1:97
  s_waitcnt lgkmcnt(0)
  v_add_f32 v36, v36, v37
  v_add_f32 v38, v38, v39
  v_add_f32 v40, v40, v41
  v_add_f32 v42, v42, v43
  v_add_f32 v36, v36, v38
  v_add_f32 v40, v40, v42
  v_add_f32 v36, v36, v40
  v_cvt_pk_bf16_f32 v16, v36, v36
  v_and_b32 v36, 0xffff0000, v16
  v_mul_f32 v36, v102, v36
  v_cvt_pk_bf16_f32 v16, v36, v36
  v_and_b32 v36, 0xffff0000, v16
  v_add_f32 v15, v250, v36
  v_cvt_pk_bf16_f32 v16, v15, v15
  v_and_b32 v15, 0xffff0000, v16
  s_cmp_eq_u32 s11, 1
  s_cbranch_scc1 L_sf63
  buffer_store_dword v15, v97, s[12:15], s70 offen sc1
  s_branch L_sd64
L_sf63:
  buffer_store_dword v15, v97, s[12:15], s70 offen
L_sd64:
  v_mul_f32 v17, v15, v15
  v_add_f32_dpp v16, v15, v15 quad_perm:[1,0,3,2] row_mask:0xf bank_mask:0xf
  s_nop 0
  v_add_f32_dpp v17, v17, v17 quad_perm:[1,0,3,2] row_mask:0xf bank_mask:0xf
  v_add_f32_dpp v16, v16, v16 quad_perm:[2,3,0,1] row_mask:0xf bank_mask:0xf
  s_nop 0
  v_add_f32_dpp v17, v17, v17 quad_perm:[2,3,0,1] row_mask:0xf bank_mask:0xf
  v_add_f32_dpp v16, v16, v16 row_half_mirror row_mask:0xf bank_mask:0xf
  s_nop 0
  v_add_f32_dpp v17, v17, v17 row_half_mirror row_mask:0xf bank_mask:0xf
  v_add_f32_dpp v16, v16, v16 row_mirror row_mask:0xf bank_mask:0xf
  s_nop 0
  v_add_f32_dpp v17, v17, v17 row_mirror row_mask:0xf bank_mask:0xf
  s_mov_b64 exec, s[74:75]
  s_cbranch_scc1 L_sf65
  buffer_store_dwordx2 v[16:17], v100, s[12:15], s73 offen sc1
  s_branch L_sd66
L_sf65:
  buffer_store_dwordx2 v[16:17], v100, s[12:15], s73 offen
L_sd66:
  s_mov_b64 exec, -1
  s_branch L_e2b58
L_idle62:
  s_sleep 5
L_e2b58:
  s_cmp_ge_u32 s20, 28
  s_cbranch_scc1 L_nf68
  s_cmp_eq_u32 s11, 1
  s_cbranch_scc1 L_sf69
  s_sleep 12
  s_branch L_sd70
L_sf69:
L_sd70:
  s_mov_b32 s31, 0
L_pd71:
  buffer_load_dwordx4 v[40:43], v4, s[12:15], s22 offen sc1
  buffer_load_dwordx4 v[44:47], v99, s[12:15], s76 offen sc1
  s_waitcnt vmcnt(0)
  v_max3_u32 v16, v40, v41, v42
  v_max3_u32 v16, v16, v43, v44
  v_max3_u32 v16, v16, v45, v46
  v_max_u32 v16, v16, v47
  v_cmp_eq_u32 vcc, -1, v16
  s_cbranch_vccz L_pdd72
  s_add_u32 s31, s31, 1
  s_cmp_ge_u32 s31, 131072
  s_cbranch_scc1 L_pdd72
  s_branch L_pd71
L_pdd72:
  v_add_f32 v18, v44, v46
  v_add_f32 v19, v45, v47
  s_nop 1
  v_permlane16_swap_b32 v18, v19
  v_add_f32 v18, v18, v19
  s_nop 1
  v_add_f32_dpp v18, v18, v18 row_ror:4 row_mask:0xf bank_mask:0xf
  s_nop 1
  v_add_f32_dpp v18, v18, v18 row_ror:8 row_mask:0xf bank_mask:0xf
  v_mov_b32 v19, v18
  s_nop 1
  v_permlane32_swap_b32 v18, v19
  v_add_f32 v18, v18, v19
  v_mul_f32 v18, 0x3b000000, v18
  v_mov_b32 v19, v18
  s_nop 1
  v_permlane16_swap_b32 v18, v19
  v_fma_f32 v19, -v18, v18, v19
  v_max_f32 v19, 0, v19
  v_cvt_pk_bf16_f32 v17, v18, v19
  v_lshlrev_b32 v18, 16, v17
  v_and_b32 v19, 0xffff0000, v17
  v_add_f32 v19, 0x3727c5ac, v19
  v_sub_f32 v40, v40, v18
  v_sub_f32 v41, v41, v18
  v_cvt_pk_bf16_f32 v17, v19, v19
  v_and_b32 v19, 0xffff0000, v17
  v_sub_f32 v42, v42, v18
  v_sub_f32 v43, v43, v18
  v_sqrt_f32 v19, v19
  v_cvt_pk_bf16_f32 v20, v40, v41
  v_lshlrev_b32 v40, 16, v20
  v_and_b32 v41, 0xffff0000, v20
  v_cvt_pk_bf16_f32 v17, v19, v19
  v_and_b32 v19, 0xffff0000, v17
  v_rcp_f32 v19, v19
  v_cvt_pk_bf16_f32 v21, v42, v43
  v_lshlrev_b32 v42, 16, v21
  v_and_b32 v43, 0xffff0000, v21
  v_mul_f32 v40, v40, v19
  v_mul_f32 v41, v41, v19
  v_mul_f32 v42, v42, v19
  v_mul_f32 v43, v43, v19
  v_cvt_pk_bf16_f32 v20, v40, v41
  v_lshlrev_b32 v40, 16, v20
  v_and_b32 v41, 0xffff0000, v20
  v_cvt_pk_bf16_f32 v21, v42, v43
  v_lshlrev_b32 v42, 16, v21
  v_and_b32 v43, 0xffff0000, v21
  v_mul_f32 v40, v40, v236
  v_mul_f32 v41, v41, v237
  v_mul_f32 v42, v42, v238
  v_mul_f32 v43, v43, v239
  v_cvt_pk_bf16_f32 v20, v40, v41
  v_lshlrev_b32 v40, 16, v20
  v_and_b32 v41, 0xffff0000, v20
  v_cvt_pk_bf16_f32 v21, v42, v43
  v_lshlrev_b32 v42, 16, v21
  v_and_b32 v43, 0xffff0000, v21
  v_add_f32 v40, v40, v240
  v_add_f32 v41, v41, v241
  v_add_f32 v42, v42, v242
  v_add_f32 v43, v43, v243
  v_cvt_pk_bf16_f32 v40, v40, v41
  v_cvt_pk_bf16_f32 v41, v42, v43
  s_nop 0
  v_mov_b32_dpp v136, v40 quad_perm:[0,1,2,3] row_mask:0xf bank_mask:0x1
  v_mov_b32_dpp v137, v41 quad_perm:[0,1,2,3] row_mask:0xf bank_mask:0x1
  v_mov_b32_dpp v138, v40 row_ror:12 row_mask:0xf bank_mask:0x1
  v_mov_b32_dpp v139, v41 row_ror:12 row_mask:0xf bank_mask:0x1
  v_mov_b32_dpp v140, v40 row_ror:4 row_mask:0xf bank_mask:0x2
  v_mov_b32_dpp v141, v41 row_ror:4 row_mask:0xf bank_mask:0x2
  v_mov_b32_dpp v142, v40 quad_perm:[0,1,2,3] row_mask:0xf bank_mask:0x2
  v_mov_b32_dpp v143, v41 quad_perm:[0,1,2,3] row_mask:0xf bank_mask:0x2
  v_mfma_f32_16x16x32_bf16 v[32:35], v[136:139], v[64:67], 0
  v_mfma_f32_16x16x32_bf16 v[36:39], v[136:139], v[80:83], 0
  v_mov_b32_dpp v144, v40 row_ror:8 row_mask:0xf bank_mask:0x4
  v_mov_b32_dpp v145, v41 row_ror:8 row_mask:0xf bank_mask:0x4
  v_mov_b32_dpp v146, v40 row_ror:4 row_mask:0xf bank_mask:0x4
  v_mov_b32_dpp v147, v41 row_ror:4 row_mask:0xf bank_mask:0x4
  v_mfma_f32_16x16x32_bf16 v[32:35], v[140:143], v[68:71], v[32:35]
  v_mfma_f32_16x16x32_bf16 v[36:39], v[140:143], v[84:87], v[36:39]
  v_mov_b32_dpp v148, v40 row_ror:12 row_mask:0xf bank_mask:0x8
  v_mov_b32_dpp v149, v41 row_ror:12 row_mask:0xf bank_mask:0x8
  v_mov_b32_dpp v150, v40 row_ror:8 row_mask:0xf bank_mask:0x8
  v_mov_b32_dpp v151, v41 row_ror:8 row_mask:0xf bank_mask:0x8
  v_mfma_f32_16x16x32_bf16 v[32:35], v[144:147], v[72:75], v[32:35]
  v_mfma_f32_16x16x32_bf16 v[36:39], v[144:147], v[88:91], v[36:39]
  v_mov_b32_dpp v152, v40 row_ror:8 row_mask:0xf bank_mask:0x1
  v_mov_b32_dpp v153, v41 row_ror:8 row_mask:0xf bank_mask:0x1
  v_mov_b32_dpp v154, v40 row_ror:4 row_mask:0xf bank_mask:0x1
  v_mov_b32_dpp v155, v41 row_ror:4 row_mask:0xf bank_mask:0x1
  v_mfma_f32_16x16x32_bf16 v[32:35], v[148:151], v[76:79], v[32:35]
  v_mfma_f32_16x16x32_bf16 v[36:39], v[148:151], v[92:95], v[36:39]
  v_mov_b32_dpp v156, v40 row_ror:12 row_mask:0xf bank_mask:0x2
  v_mov_b32_dpp v157, v41 row_ror:12 row_mask:0xf bank_mask:0x2
  v_mov_b32_dpp v158, v40 row_ror:8 row_mask:0xf bank_mask:0x2
  v_mov_b32_dpp v159, v41 row_ror:8 row_mask:0xf bank_mask:0x2
  v_mfma_f32_16x16x32_bf16 v[32:35], v[152:155], v[200:203], v[32:35]
  v_mfma_f32_16x16x32_bf16 v[36:39], v[152:155], v[216:219], v[36:39]
  v_mov_b32_dpp v160, v40 quad_perm:[0,1,2,3] row_mask:0xf bank_mask:0x4
  v_mov_b32_dpp v161, v41 quad_perm:[0,1,2,3] row_mask:0xf bank_mask:0x4
  v_mov_b32_dpp v162, v40 row_ror:12 row_mask:0xf bank_mask:0x4
  v_mov_b32_dpp v163, v41 row_ror:12 row_mask:0xf bank_mask:0x4
  v_mfma_f32_16x16x32_bf16 v[32:35], v[156:159], v[204:207], v[32:35]
  v_mfma_f32_16x16x32_bf16 v[36:39], v[156:159], v[220:223], v[36:39]
  v_mov_b32_dpp v164, v40 row_ror:4 row_mask:0xf bank_mask:0x8
  v_mov_b32_dpp v165, v41 row_ror:4 row_mask:0xf bank_mask:0x8
  v_mov_b32_dpp v166, v40 quad_perm:[0,1,2,3] row_mask:0xf bank_mask:0x8
  v_mov_b32_dpp v167, v41 quad_perm:[0,1,2,3] row_mask:0xf bank_mask:0x8
  v_mfma_f32_16x16x32_bf16 v[32:35], v[160:163], v[208:211], v[32:35]
  v_mfma_f32_16x16x32_bf16 v[36:39], v[160:163], v[224:227], v[36:39]
  v_mfma_f32_16x16x32_bf16 v[32:35], v[164:167], v[212:215], v[32:35]
  v_mfma_f32_16x16x32_bf16 v[36:39], v[164:167], v[228:231], v[36:39]
  s_nop 6
  ds_write_b128 v101, v[32:35] offset:0
  ds_write_b128 v101, v[36:39] offset:1024
  s_waitcnt lgkmcnt(0)
  s_barrier
  ds_read_b32 v16, v10 offset:4352
  ds_read_b32 v17, v10 offset:6400
  ds_read_b32 v18, v10 offset:8448
  ds_read_b32 v19, v10 offset:10496
  ds_read_b32 v20, v10 offset:12544
  ds_read_b32 v21, v10 offset:14592
  ds_read_b32 v22, v10 offset:16640
  ds_read_b32 v23, v10 offset:18688
  s_waitcnt lgkmcnt(0)
  v_add_f32 v16, v16, v17
  v_add_f32 v18, v18, v19
  v_add_f32 v20, v20, v21
  v_add_f32 v22, v22, v23
  v_add_f32 v16, v16, v18
  v_add_f32 v20, v20, v22
  v_add_f32 v16, v16, v20
  v_cvt_pk_bf16_f32 v17, v16, v16
  v_and_b32 v16, 0xffff0000, v17
  v_mov_b32 v17, v16
  v_mul_f32 v18, v16, v16
  v_mul_f32 v18, 0x3d372713, v18
  v_fma_f32 v18, v18, v16, v16
  v_mul_f32 v18, 0xc0135761, v18
  v_exp_f32 v18, v18
  v_permlane32_swap_b32 v16, v17
  v_add_f32 v18, 1.0, v18
  v_rcp_f32 v18, v18
  s_mov_b32 exec_hi, 0
  v_mul_f32 v16, v16, v18
  v_cvt_pk_bf16_f32 v18, v16, v16
  v_and_b32 v16, 0xffff0000, v18
  v_mul_f32 v16, v16, v17
  v_cvt_pk_bf16_f32 v16, v16, v16
  ds_write_b16 v232, v16
  s_mov_b64 exec, -1
  s_waitcnt lgkmcnt(0)
  s_barrier
  ds_read_b128 v[16:19], v96 offset:21952
  ds_read_b128 v[20:23], v96 offset:22016
  s_waitcnt lgkmcnt(1)
  v_mfma_f32_16x16x32_bf16 v[32:35], v[16:19], v[168:171], 0
  v_mfma_f32_16x16x32_bf16 v[36:39], v[16:19], v[172:175], 0
  s_waitcnt lgkmcnt(0)
  v_mfma_f32_16x16x32_bf16 v[32:35], v[20:23], v[184:187], v[32:35]
  v_mfma_f32_16x16x32_bf16 v[36:39], v[20:23], v[188:191], v[36:39]
  v_mfma_f32_16x16x32_bf16 v[40:43], v[16:19], v[176:179], 0
  v_mfma_f32_16x16x32_bf16 v[40:43], v[20:23], v[192:195], v[40:43]
  v_mfma_f32_16x16x32_bf16 v[44:47], v[16:19], v[180:183], 0
  v_mfma_f32_16x16x32_bf16 v[44:47], v[20:23], v[196:199], v[44:47]
  s_cmp_eq_u32 s11, 1
  s_nop 2
  v_mov_b32_dpp v32, v36 quad_perm:[0,1,2,3] row_mask:0x2 bank_mask:0xf
  v_mov_b32_dpp v33, v37 quad_perm:[0,1,2,3] row_mask:0x2 bank_mask:0xf
  v_mov_b32_dpp v34, v38 quad_perm:[0,1,2,3] row_mask:0x2 bank_mask:0xf
  v_mov_b32_dpp v35, v39 quad_perm:[0,1,2,3] row_mask:0x2 bank_mask:0xf
  v_mov_b32_dpp v32, v40 quad_perm:[0,1,2,3] row_mask:0x4 bank_mask:0xf
  v_mov_b32_dpp v33, v41 quad_perm:[0,1,2,3] row_mask:0x4 bank_mask:0xf
  v_mov_b32_dpp v34, v42 quad_perm:[0,1,2,3] row_mask:0x4 bank_mask:0xf
  v_mov_b32_dpp v35, v43 quad_perm:[0,1,2,3] row_mask:0x4 bank_mask:0xf
  v_mov_b32_dpp v32, v44 quad_perm:[0,1,2,3] row_mask:0x8 bank_mask:0xf
  v_mov_b32_dpp v33, v45 quad_perm:[0,1,2,3] row_mask:0x8 bank_mask:0xf
  v_mov_b32_dpp v34, v46 quad_perm:[0,1,2,3] row_mask:0x8 bank_mask:0xf
  v_mov_b32_dpp v35, v47 quad_perm:[0,1,2,3] row_mask:0x8 bank_mask:0xf
  s_cbranch_scc1 L_sf73
  buffer_store_dwordx4 v[32:35], v98, s[12:15], s9 offen sc1
  s_sleep 10
  s_branch L_sd74
L_sf73:
  buffer_store_dwordx4 v[32:35], v98, s[12:15], s9 offen
L_sd74:
  s_branch L_e467
L_nf68:
  s_cmp_lg_u32 s11, 1
  s_cbranch_scc1 L_e467
  s_cmp_lg_u32 s3, 7
  s_cbranch_scc1 L_e467
  s_cmp_lg_u32 s20, 31
  s_cbranch_scc1 L_e467
  s_mov_b32 s31, 0
L_pd75:
  buffer_load_dwordx4 v[44:47], v99, s[12:15], s76 offen sc1
  s_waitcnt vmcnt(0)
  v_max3_u32 v16, v44, v45, v46
  v_max_u32 v16, v16, v47
  v_cmp_eq_u32 vcc, -1, v16
  s_cbranch_vccz L_pdd76
  s_add_u32 s31, s31, 1
  s_cmp_ge_u32 s31, 131072
  s_cbranch_scc1 L_pdd76
  s_sleep 2
  s_branch L_pd75
L_pdd76:
  buffer_wbl2 sc1
L_e467:
  s_cmp_ge_u32 s3, 7
  s_cbranch_scc1 L_sp78
  s_mov_b32 s31, 0
L_pd79:
  buffer_load_dwordx4 v[36:39], v99, s[12:15], s69 offen sc1
  s_waitcnt vmcnt(0)
  v_max3_u32 v16, v36, v37, v38
  v_max_u32 v16, v16, v39
  v_cmp_eq_u32 vcc, -1, v16
  s_cbranch_vccz L_pdd80
  s_add_u32 s31, s31, 1
  s_cmp_ge_u32 s31, 131072
  s_cbranch_scc1 L_pdd80
  s_branch L_pd79
L_pdd80:
  v_permlane32_swap_b32 v36, v38
  v_permlane32_swap_b32 v37, v39
  v_add_f32 v36, v36, v38
  v_add_f32 v37, v37, v39
  s_nop 1
  v_permlane16_swap_b32 v36, v37
  v_add_f32 v36, v36, v37
  ds_write_b32 v10, v36 offset:23040
L_sp78:
  s_waitcnt lgkmcnt(0)
  s_barrier
  s_cmp_lg_u32 s3, 0
  s_cbranch_scc1 L_dend77
  ds_read2st64_b32 v[36:37], v97 offset0:90 offset1:91
  ds_read2st64_b32 v[38:39], v97 offset0:92 offset1:93
  ds_read2st64_b32 v[40:41], v97 offset0:94 offset1:95
  ds_read_b32 v42, v97 offset:24576
  s_waitcnt lgkmcnt(0)
  v_add_f32 v36, v36, v37
  v_add_f32 v38, v38, v39
  v_add_f32 v40, v40, v41
  v_add_f32 v36, v36, v38
  v_add_f32 v40, v40, v42
  v_add_f32 v36, v36, v40
  v_cvt_pk_bf16_f32 v16, v36, v36
  v_and_b32 v36, 0xffff0000, v16
  v_mul_f32 v36, v103, v36
  v_cvt_pk_bf16_f32 v16, v36, v36
  v_and_b32 v36, 0xffff0000, v16
  v_add_f32 v36, v15, v36
  v_cvt_pk_bf16_f32 v36, v36, v36
  buffer_store_short v36, v7, s[88:91], s26 offen
L_dend77:
  s_endpgm
L_exit:
  s_endpgm
.section .rodata,"a"
.p2align 6
.amdhsa_kernel adaLN_cond__gqa_block_cached__geglu_ffn__decode_kernel
  .amdhsa_next_free_vgpr 256
  .amdhsa_next_free_sgpr 102
  .amdhsa_accum_offset 256
  .amdhsa_group_segment_fixed_size 0
  .amdhsa_kernarg_size 112
  .amdhsa_user_sgpr_count 2
  .amdhsa_user_sgpr_kernarg_segment_ptr 1
  .amdhsa_system_sgpr_workgroup_id_x 1
  .amdhsa_float_denorm_mode_32 3
.end_amdhsa_kernel
```
